```python
import torch

def _softmax(x, axis=-1):
    return torch.softmax(x, dim=axis)
def _gelu(x):
    return torch.nn.functional.gelu(x, approximate="tanh")
def _silu(x):
    return torch.nn.functional.silu(x)
def _sigmoid(x):
    return torch.sigmoid(x)
def _layernorm(x, axis=-1, eps=1e-5):
    m = x.mean(dim=axis, keepdim=True)
    v = x.var(dim=axis, keepdim=True, unbiased=False)
    return (x - m) / torch.sqrt(v + eps)
def _scatter_add(tgt, idx, src, axis=0):
    return tgt.clone().index_add_(axis, idx, src)
def _segment_sum(src, seg, n):
    out = torch.zeros((n,) + src.shape[1:], dtype=src.dtype)
    return out.index_add_(0, seg, src)
def _pad(x, pw):
    flat = tuple(v for pair in reversed(pw) for v in pair)
    return torch.nn.functional.pad(x, flat)

kernel_name = 'sequential_preLN__gqa_block_cached__dense_activation_silu__decode'

def setup_inputs():

    _w = (lambda a: (lambda t: t.to(torch.bfloat16) if t.is_floating_point() else t)(torch.as_tensor(a)))
    def _A_setup():
        B, Sq, D = 1, 1, 1024
        Hq, Hkv, Sk, Dh = 32, 4, 65536, 128
        assert Hq % Hkv == 0, (Hq, Hkv)
        return {
            "x": _w((lambda *s: torch.randn(*s, dtype=torch.bfloat16) * 0.05)(B, Sq, D)),
            "k_cache": _w((lambda *s: torch.randn(*s, dtype=torch.bfloat16) * 3.2)(B, Hkv, Sk, Dh)),
            "v_cache": _w((lambda *s: torch.randn(*s, dtype=torch.bfloat16) * 0.8)(B, Hkv, Sk, Dh)),
            "wq": _w((lambda *s: torch.randn(*s, dtype=torch.bfloat16) * 3.2)(D, Hq * Dh) * (D ** -0.5)),
            "wo": _w((lambda *s: torch.randn(*s, dtype=torch.bfloat16) * 0.8)(Hq * Dh, D) * ((Hq * Dh) ** -0.5)),
        }
    _A_in = _A_setup()

    def _B_setup():
        B, S, D, F = 1, 1, 1024, 3584
        return {
            "x": _w((lambda *s: torch.randn(*s, dtype=torch.bfloat16) * 0.05)(B, S, D)),
            "w1": _w((lambda *s: torch.randn(*s, dtype=torch.bfloat16) * 3.2)(D, F) * (D ** -0.5)),
            "w2": _w((lambda *s: torch.randn(*s, dtype=torch.bfloat16) * 0.8)(F, D) * (F ** -0.5)),
        }
    _B_in = _B_setup()

    return {
        "A_x": _A_in["x"],
        "A_k_cache": _A_in["k_cache"],
        "A_v_cache": _A_in["v_cache"],
        "A_wq": _A_in["wq"],
        "A_wo": _A_in["wo"],
        "B_x": _B_in["x"],
        "B_w1": _B_in["w1"],
        "B_w2": _B_in["w2"],
    }

def reference(A_x, A_k_cache, A_v_cache, A_wq, A_wo, B_x, B_w1, B_w2):
    def _A_ref(x, k_cache, v_cache, wq, wo):
        B, Sq, D = x.shape
        Hq, Dh = 32, 128
        Hkv = k_cache.shape[1]
        rep = Hq // Hkv
        q = (lambda x, *d: x.permute(*d))((x @ wq).reshape(B, Sq, Hq, Dh), 0, 2, 1, 3)
        k = (lambda x, n, axis: torch.repeat_interleave(x, n, dim=axis))(k_cache, rep, axis=1)
        v = (lambda x, n, axis: torch.repeat_interleave(x, n, dim=axis))(v_cache, rep, axis=1)
        scores = torch.einsum("bhqd,bhkd->bhqk", q, k) * (Dh ** -0.5)
        p = _softmax(scores, axis=-1)
        o = torch.einsum("bhqk,bhkd->bhqd", p, v)
        return (lambda x, *d: x.permute(*d))(o, 0, 2, 1, 3).reshape(B, Sq, Hq * Dh) @ wo

    def _B_ref(x, w1, w2):
        h = torch.einsum("bsd,df->bsf", x, w1)
        h = _silu(h)
        out = torch.einsum("bsf,fd->bsd", h, w2)
        return out

    x = A_x
    h = x + _A_ref(_layernorm(x, axis=-1), A_k_cache, A_v_cache, A_wq, A_wo)
    h2 = h + _B_ref(_layernorm(h, axis=-1), B_w1, B_w2)
    return h2
```

```asm
; @launch grid=(256,1,1) block=(512,1,1) lds=49152
.amdgcn_target "amdgcn-amd-amdhsa--gfx950"
.text
.globl sequential_preLN__gqa_block_cached__dense_activation_silu__decode_kernel
.p2align 8
.type sequential_preLN__gqa_block_cached__dense_activation_silu__decode_kernel,@function
sequential_preLN__gqa_block_cached__dense_activation_silu__decode_kernel:
    s_cmp_ge_u32 s2, 0x100
    s_cbranch_scc1 L_end
    s_load_dwordx16 s[64:79], s[0:1], 0
    s_load_dwordx4 s[80:83], s[0:1], 64
    s_load_dwordx2 s[84:85], s[0:1], 80
    v_and_b32 v1, 63, v0
    v_lshrrev_b32 v8, 6, v0
    s_nop 0
    v_readfirstlane_b32 s3, v8
    v_lshlrev_b32 v3, 4, v1
    v_bfe_u32 v8, v1, 1, 1
    v_lshlrev_b32 v8, 10, v8
    v_bfe_u32 v9, v1, 2, 2
    v_lshl_add_u32 v8, v9, 8, v8
    v_lshrrev_b32 v9, 4, v1
    v_lshl_add_u32 v8, v9, 5, v8
    v_and_b32 v9, 1, v1
    v_lshl_add_u32 v2, v9, 4, v8
    v_mov_b32 v4, 0xffffff00
    s_and_b32 s4, s2, 3
    s_lshr_b32 s5, s2, 2
    s_lshr_b32 s90, s2, 5
    s_lshl_b32 s90, s90, 3
    s_and_b32 s91, s2, 7
    s_or_b32 s90, s90, s91
    s_bfe_u32 s91, s2, 0x20003
    s_mov_b32 s54, 0x05040100
    s_mov_b32 s55, 0x07060302
    s_mov_b32 s56, 0xffff0000
    s_mov_b32 s57, 0x3db504f3
    s_mov_b32 s58, 0x3fb8aa3b
    s_mov_b32 s59, 0x80
    s_mov_b32 s60, 0xffff0000
    s_mov_b32 s61, 0xffff0000
    s_lshl_b32 s6, s5, 3
    s_add_u32 s6, s6, s3
    s_lshl_b32 s6, s6, 12
    s_lshl_b32 s7, s4, 24
    s_add_u32 s49, s6, s7
    s_mov_b32 s50, s49
    v_lshrrev_b32 v9, 4, v1
    v_and_b32 v8, 15, v1
    v_lshlrev_b32 v8, 4, v8
    v_lshl_add_u32 v10, v9, 15, v8
    v_lshlrev_b32 v11, 3, v9
    v_lshlrev_b32 v12, 5, v1
    s_waitcnt lgkmcnt(0)
    s_mov_b32 s20, s64
    s_and_b32 s21, s65, 0xffff
    s_mov_b32 s22, 2048
    s_mov_b32 s23, 0x20000
    s_mov_b32 s24, s70
    s_and_b32 s25, s71, 0xffff
    s_mov_b32 s26, 8388608
    s_mov_b32 s27, 0x20000
    s_mov_b32 s8, s66
    s_and_b32 s9, s67, 0xffff
    s_mov_b32 s10, 67108864
    s_mov_b32 s11, 0x20000
    buffer_load_dwordx4 v[240:243], v12, s[20:23], 0 offen
    buffer_load_dwordx4 v[244:247], v12, s[20:23], 0 offen offset:16
    s_lshr_b32 s95, s2, 6
    s_lshl_b32 s95, s95, 4
    s_add_u32 s95, s95, s3
    s_and_b32 s7, s2, 1
    s_mul_i32 s6, s7, 11
    s_add_u32 s6, s6, s95
    s_mul_i32 s7, s7, s3
    s_cmp_ge_u32 s7, 5
    s_cselect_b32 s6, 64, s6
    s_add_u32 s95, s95, 8
    s_and_b32 s7, s2, 1
    s_lshl_b32 s7, s7, 3
    s_add_u32 s7, s7, s3
    s_cmp_ge_u32 s7, 3
    s_cselect_b32 s95, 64, s95
    s_bfe_u32 s94, s2, 0x50001
    s_lshl_b32 s94, s94, 8
    s_lshl_b32 s7, s6, 5
    buffer_load_dwordx2 v[248:249], v11, s[20:23], s7 offen
    s_lshl_b32 s7, s95, 5
    buffer_load_dwordx2 v[250:251], v11, s[20:23], s7 offen
    s_lshl_b32 s6, s6, 17
    s_add_u32 s6, s6, s94
    buffer_load_dwordx4 v[192:195], v10, s[24:27], s6 offen nt
    s_add_u32 s6, s6, 8192
    buffer_load_dwordx4 v[196:199], v10, s[24:27], s6 offen nt
    s_add_u32 s6, s6, 8192
    buffer_load_dwordx4 v[200:203], v10, s[24:27], s6 offen nt
    s_add_u32 s6, s6, 8192
    buffer_load_dwordx4 v[204:207], v10, s[24:27], s6 offen nt
    s_lshl_b32 s6, s95, 17
    s_add_u32 s6, s6, s94
    buffer_load_dwordx4 v[208:211], v10, s[24:27], s6 offen nt
    s_add_u32 s6, s6, 8192
    buffer_load_dwordx4 v[212:215], v10, s[24:27], s6 offen nt
    s_add_u32 s6, s6, 8192
    buffer_load_dwordx4 v[216:219], v10, s[24:27], s6 offen nt
    s_add_u32 s6, s6, 8192
    buffer_load_dwordx4 v[220:223], v10, s[24:27], s6 offen nt
    s_barrier
    buffer_load_dwordx4 v[64:67], v2, s[8:11], s49 offen offset:0 nt
    buffer_load_dwordx4 v[68:71], v2, s[8:11], s49 offen offset:128 nt
    buffer_load_dwordx4 v[72:75], v2, s[8:11], s49 offen offset:2048 nt
    buffer_load_dwordx4 v[76:79], v2, s[8:11], s49 offen offset:2176 nt
    s_add_u32 s49, s49, 0x200000
    buffer_load_dwordx4 v[80:83], v2, s[8:11], s49 offen offset:0 nt
    buffer_load_dwordx4 v[84:87], v2, s[8:11], s49 offen offset:128 nt
    s_mov_b32 s12, s68
    s_and_b32 s13, s69, 0xffff
    s_mov_b32 s14, 67108864
    s_mov_b32 s15, 0x20000
    s_mov_b32 s16, s84
    s_and_b32 s17, s85, 0xffff
    s_mov_b32 s18, 268435456
    s_mov_b32 s19, 0x20000
    s_mov_b32 s28, s72
    s_and_b32 s29, s73, 0xffff
    s_mov_b32 s30, 8388608
    s_mov_b32 s31, 0x20000
    s_mov_b32 s32, s76
    s_and_b32 s33, s77, 0xffff
    s_mov_b32 s34, 7340032
    s_mov_b32 s35, 0x20000
    s_mov_b32 s36, s78
    s_and_b32 s37, s79, 0xffff
    s_mov_b32 s38, 7340032
    s_mov_b32 s39, 0x20000
    s_mov_b32 s40, s80
    s_and_b32 s41, s81, 0xffff
    s_mov_b32 s42, 2048
    s_mov_b32 s43, 0x20000
    s_mov_b32 s44, s82
    s_and_b32 s45, s83, 0xffff
    s_mov_b32 s46, 256
    s_mov_b32 s47, 0x20000
    s_load_dword s53, s[84:85], 0
    s_waitcnt vmcnt(16)
    v_lshlrev_b32 v32, 16, v240
    v_and_b32 v33, s56, v240
    v_lshlrev_b32 v34, 16, v241
    v_and_b32 v35, s56, v241
    v_lshlrev_b32 v36, 16, v242
    v_and_b32 v37, s56, v242
    v_lshlrev_b32 v38, 16, v243
    v_and_b32 v39, s56, v243
    v_lshlrev_b32 v40, 16, v244
    v_and_b32 v41, s56, v244
    v_lshlrev_b32 v42, 16, v245
    v_and_b32 v43, s56, v245
    v_lshlrev_b32 v44, 16, v246
    v_and_b32 v45, s56, v246
    v_lshlrev_b32 v46, 16, v247
    v_and_b32 v47, s56, v247
    v_add_f32 v10, v32, v33
    v_add_f32 v10, v10, v34
    v_add_f32 v10, v10, v35
    v_add_f32 v10, v10, v36
    v_add_f32 v10, v10, v37
    v_add_f32 v10, v10, v38
    v_add_f32 v10, v10, v39
    v_add_f32 v10, v10, v40
    v_add_f32 v10, v10, v41
    v_add_f32 v10, v10, v42
    v_add_f32 v10, v10, v43
    v_add_f32 v10, v10, v44
    v_add_f32 v10, v10, v45
    v_add_f32 v10, v10, v46
    v_add_f32 v10, v10, v47
    v_mov_b32 v11, v10
    s_nop 1
    v_permlane32_swap_b32 v11, v10
    v_add_f32 v10, v10, v11
    v_mov_b32 v11, v10
    s_nop 1
    v_permlane16_swap_b32 v11, v10
    v_add_f32 v10, v10, v11
    s_nop 1
    v_add_f32_dpp v10, v10, v10 row_ror:8 row_mask:0xf bank_mask:0xf
    s_nop 1
    v_add_f32_dpp v10, v10, v10 row_ror:4 row_mask:0xf bank_mask:0xf
    s_nop 1
    v_add_f32_dpp v10, v10, v10 row_ror:2 row_mask:0xf bank_mask:0xf
    s_nop 1
    v_add_f32_dpp v10, v10, v10 row_ror:1 row_mask:0xf bank_mask:0xf
    v_mul_f32 v10, 0x3a800000, v10
    v_sub_f32 v32, v32, v10
    v_sub_f32 v33, v33, v10
    v_sub_f32 v34, v34, v10
    v_sub_f32 v35, v35, v10
    v_sub_f32 v36, v36, v10
    v_sub_f32 v37, v37, v10
    v_sub_f32 v38, v38, v10
    v_sub_f32 v39, v39, v10
    v_sub_f32 v40, v40, v10
    v_sub_f32 v41, v41, v10
    v_sub_f32 v42, v42, v10
    v_sub_f32 v43, v43, v10
    v_sub_f32 v44, v44, v10
    v_sub_f32 v45, v45, v10
    v_sub_f32 v46, v46, v10
    v_sub_f32 v47, v47, v10
    v_mul_f32 v9, v32, v32
    v_fmac_f32 v9, v33, v33
    v_fmac_f32 v9, v34, v34
    v_fmac_f32 v9, v35, v35
    v_fmac_f32 v9, v36, v36
    v_fmac_f32 v9, v37, v37
    v_fmac_f32 v9, v38, v38
    v_fmac_f32 v9, v39, v39
    v_fmac_f32 v9, v40, v40
    v_fmac_f32 v9, v41, v41
    v_fmac_f32 v9, v42, v42
    v_fmac_f32 v9, v43, v43
    v_fmac_f32 v9, v44, v44
    v_fmac_f32 v9, v45, v45
    v_fmac_f32 v9, v46, v46
    v_fmac_f32 v9, v47, v47
    v_mov_b32 v11, v9
    s_nop 1
    v_permlane32_swap_b32 v11, v9
    v_add_f32 v9, v9, v11
    v_mov_b32 v11, v9
    s_nop 1
    v_permlane16_swap_b32 v11, v9
    v_add_f32 v9, v9, v11
    s_nop 1
    v_add_f32_dpp v9, v9, v9 row_ror:8 row_mask:0xf bank_mask:0xf
    s_nop 1
    v_add_f32_dpp v9, v9, v9 row_ror:4 row_mask:0xf bank_mask:0xf
    s_nop 1
    v_add_f32_dpp v9, v9, v9 row_ror:2 row_mask:0xf bank_mask:0xf
    s_nop 1
    v_add_f32_dpp v9, v9, v9 row_ror:1 row_mask:0xf bank_mask:0xf
    v_cvt_pk_bf16_f32 v8, v10, v10
    v_lshlrev_b32 v8, 16, v8
    v_mul_f32 v9, 0x3a800000, v9
    v_cvt_pk_bf16_f32 v9, v9, v9
    v_lshlrev_b32 v9, 16, v9
    v_add_f32 v9, 0x3727c5ac, v9
    v_cvt_pk_bf16_f32 v9, v9, v9
    v_lshlrev_b32 v9, 16, v9
    v_sqrt_f32 v9, v9
    s_nop 0
    v_cvt_pk_bf16_f32 v9, v9, v9
    v_lshlrev_b32 v9, 16, v9
    v_rcp_f32 v9, v9
    v_readfirstlane_b32 s92, v10
    s_waitcnt vmcnt(14)
    v_lshlrev_b32 v48, 16, v248
    v_and_b32 v49, s56, v248
    v_lshlrev_b32 v50, 16, v249
    v_and_b32 v51, s56, v249
    v_sub_f32 v48, v48, v8
    v_sub_f32 v49, v49, v8
    v_sub_f32 v50, v50, v8
    v_sub_f32 v51, v51, v8
    v_cvt_pk_bf16_f32 v52, v48, v49
    v_cvt_pk_bf16_f32 v53, v50, v51
    v_lshlrev_b32 v48, 16, v52
    v_and_b32 v49, s56, v52
    v_lshlrev_b32 v50, 16, v53
    v_and_b32 v51, s56, v53
    v_mul_f32 v48, v48, v9
    v_mul_f32 v49, v49, v9
    v_mul_f32 v50, v50, v9
    v_mul_f32 v51, v51, v9
    v_cvt_pk_bf16_f32 v52, v48, v49
    v_cvt_pk_bf16_f32 v53, v50, v51
    v_mov_b32 v16, v52
    v_mov_b32 v17, v53
    v_lshlrev_b32 v48, 16, v250
    v_and_b32 v49, s56, v250
    v_lshlrev_b32 v50, 16, v251
    v_and_b32 v51, s56, v251
    v_sub_f32 v48, v48, v8
    v_sub_f32 v49, v49, v8
    v_sub_f32 v50, v50, v8
    v_sub_f32 v51, v51, v8
    v_cvt_pk_bf16_f32 v18, v48, v49
    v_cvt_pk_bf16_f32 v19, v50, v51
    v_lshlrev_b32 v48, 16, v18
    v_and_b32 v49, s56, v18
    v_lshlrev_b32 v50, 16, v19
    v_and_b32 v51, s56, v19
    v_mul_f32 v48, v48, v9
    v_mul_f32 v49, v49, v9
    v_mul_f32 v50, v50, v9
    v_mul_f32 v51, v51, v9
    v_cvt_pk_bf16_f32 v18, v48, v49
    v_cvt_pk_bf16_f32 v19, v50, v51
    s_waitcnt vmcnt(10)
    v_perm_b32 v240, v196, v192, s54
    v_perm_b32 v241, v204, v200, s54
    v_perm_b32 v242, v196, v192, s55
    v_perm_b32 v243, v204, v200, s55
    v_perm_b32 v244, v197, v193, s54
    v_perm_b32 v245, v205, v201, s54
    v_perm_b32 v246, v197, v193, s55
    v_perm_b32 v247, v205, v201, s55
    v_perm_b32 v248, v198, v194, s54
    v_perm_b32 v249, v206, v202, s54
    v_perm_b32 v250, v198, v194, s55
    v_perm_b32 v251, v206, v202, s55
    v_perm_b32 v252, v199, v195, s54
    v_perm_b32 v253, v207, v203, s54
    v_perm_b32 v254, v199, v195, s55
    v_perm_b32 v255, v207, v203, s55
    v_mfma_f32_16x16x16_bf16 v[32:35], v[16:17], v[240:241], 0
    v_mfma_f32_16x16x16_bf16 v[36:39], v[16:17], v[242:243], 0
    v_mfma_f32_16x16x16_bf16 v[40:43], v[16:17], v[244:245], 0
    v_mfma_f32_16x16x16_bf16 v[44:47], v[16:17], v[246:247], 0
    v_mfma_f32_16x16x16_bf16 v[48:51], v[16:17], v[248:249], 0
    v_mfma_f32_16x16x16_bf16 v[52:55], v[16:17], v[250:251], 0
    v_mfma_f32_16x16x16_bf16 v[56:59], v[16:17], v[252:253], 0
    v_mfma_f32_16x16x16_bf16 v[60:63], v[16:17], v[254:255], 0
    s_cmp_eq_u32 s95, 64
    s_cbranch_scc1 L_q1
    s_waitcnt vmcnt(6)
    s_nop 4
    v_perm_b32 v240, v212, v208, s54
    v_perm_b32 v241, v220, v216, s54
    v_perm_b32 v242, v212, v208, s55
    v_perm_b32 v243, v220, v216, s55
    v_perm_b32 v244, v213, v209, s54
    v_perm_b32 v245, v221, v217, s54
    v_perm_b32 v246, v213, v209, s55
    v_perm_b32 v247, v221, v217, s55
    v_perm_b32 v248, v214, v210, s54
    v_perm_b32 v249, v222, v218, s54
    v_perm_b32 v250, v214, v210, s55
    v_perm_b32 v251, v222, v218, s55
    v_perm_b32 v252, v215, v211, s54
    v_perm_b32 v253, v223, v219, s54
    v_perm_b32 v254, v215, v211, s55
    v_perm_b32 v255, v223, v219, s55
    v_mfma_f32_16x16x16_bf16 v[32:35], v[18:19], v[240:241], v[32:35]
    v_mfma_f32_16x16x16_bf16 v[36:39], v[18:19], v[242:243], v[36:39]
    v_mfma_f32_16x16x16_bf16 v[40:43], v[18:19], v[244:245], v[40:43]
    v_mfma_f32_16x16x16_bf16 v[44:47], v[18:19], v[246:247], v[44:47]
    v_mfma_f32_16x16x16_bf16 v[48:51], v[18:19], v[248:249], v[48:51]
    v_mfma_f32_16x16x16_bf16 v[52:55], v[18:19], v[250:251], v[52:55]
    v_mfma_f32_16x16x16_bf16 v[56:59], v[18:19], v[252:253], v[56:59]
    v_mfma_f32_16x16x16_bf16 v[60:63], v[18:19], v[254:255], v[60:63]
L_q1:
    s_nop 4
    v_cndmask_b32 v20, v32, v48, s[60:61]
    v_cndmask_b32 v21, v36, v52, s[60:61]
    v_cndmask_b32 v22, v40, v56, s[60:61]
    v_cndmask_b32 v23, v44, v60, s[60:61]
    v_and_b32 v8, 15, v1
    v_lshlrev_b32 v8, 5, v8
    v_bfe_u32 v9, v1, 4, 1
    v_lshl_add_u32 v8, v9, 4, v8
    s_lshl_b32 s6, s3, 9
    v_add_u32 v8, s6, v8
    ds_write_b128 v8, v[20:23] offset:0
    s_waitcnt lgkmcnt(0)
    s_add_u32 s53, s53, 1
    s_and_b32 s51, s53, 0xff
    s_and_b32 s52, s53, 0xffff
    s_and_b32 s48, s53, 3
    s_barrier
    s_cmp_lg_u32 s3, 0
    s_cbranch_scc1 L_noq
    v_and_b32 v8, 0x1f0, v3
    ds_read_b128 v[32:35], v8 offset:0
    ds_read_b128 v[36:39], v8 offset:512
    ds_read_b128 v[40:43], v8 offset:1024
    ds_read_b128 v[44:47], v8 offset:1536
    ds_read_b128 v[48:51], v8 offset:2048
    ds_read_b128 v[52:55], v8 offset:2560
    ds_read_b128 v[56:59], v8 offset:3072
    ds_read_b128 v[60:63], v8 offset:3584
    s_waitcnt lgkmcnt(0)
    v_add_f32 v32, v32, v36
    v_add_f32 v33, v33, v37
    v_add_f32 v34, v34, v38
    v_add_f32 v35, v35, v39
    v_add_f32 v32, v32, v40
    v_add_f32 v33, v33, v41
    v_add_f32 v34, v34, v42
    v_add_f32 v35, v35, v43
    v_add_f32 v32, v32, v44
    v_add_f32 v33, v33, v45
    v_add_f32 v34, v34, v46
    v_add_f32 v35, v35, v47
    v_add_f32 v32, v32, v48
    v_add_f32 v33, v33, v49
    v_add_f32 v34, v34, v50
    v_add_f32 v35, v35, v51
    v_add_f32 v32, v32, v52
    v_add_f32 v33, v33, v53
    v_add_f32 v34, v34, v54
    v_add_f32 v35, v35, v55
    v_add_f32 v32, v32, v56
    v_add_f32 v33, v33, v57
    v_add_f32 v34, v34, v58
    v_add_f32 v35, v35, v59
    v_add_f32 v32, v32, v60
    v_add_f32 v33, v33, v61
    v_add_f32 v34, v34, v62
    v_add_f32 v35, v35, v63
    s_lshl_b32 s6, s94, 4
    s_lshr_b32 s7, s2, 6
    s_lshl_b32 s7, s7, 10
    s_add_u32 s6, s6, s7
    s_and_b32 s7, s2, 1
    s_lshl_b32 s7, s7, 9
    s_add_u32 s6, s6, s7
    s_add_u32 s6, s6, 65536
    s_mov_b32 exec_hi, 0
    v_and_b32 v32, -4, v32
    v_or_b32 v32, s48, v32
    v_and_b32 v33, -4, v33
    v_or_b32 v33, s48, v33
    v_and_b32 v34, -4, v34
    v_or_b32 v34, s48, v34
    v_and_b32 v35, -4, v35
    v_or_b32 v35, s48, v35
    buffer_store_dwordx4 v[32:35], v8, s[16:19], s6 offen sc1
    s_mov_b64 exec, -1
L_noq:
    s_waitcnt vmcnt(5)
    buffer_load_dwordx4 v[88:91], v2, s[8:11], s49 offen offset:2048 nt
    s_waitcnt vmcnt(5)
    buffer_load_dwordx4 v[92:95], v2, s[8:11], s49 offen offset:2176 nt
    s_add_u32 s49, s49, 0x200000
    s_waitcnt vmcnt(5)
    buffer_load_dwordx4 v[96:99], v2, s[8:11], s49 offen offset:0 nt
    s_waitcnt vmcnt(5)
    buffer_load_dwordx4 v[100:103], v2, s[8:11], s49 offen offset:128 nt
    s_waitcnt vmcnt(5)
    buffer_load_dwordx4 v[104:107], v2, s[8:11], s49 offen offset:2048 nt
    s_waitcnt vmcnt(5)
    buffer_load_dwordx4 v[108:111], v2, s[8:11], s49 offen offset:2176 nt
    s_add_u32 s49, s49, 0x200000
    s_waitcnt vmcnt(5)
    buffer_load_dwordx4 v[112:115], v2, s[8:11], s49 offen offset:0 nt
    s_waitcnt vmcnt(5)
    buffer_load_dwordx4 v[116:119], v2, s[8:11], s49 offen offset:128 nt
    s_waitcnt vmcnt(5)
    buffer_load_dwordx4 v[120:123], v2, s[8:11], s49 offen offset:2048 nt
    s_waitcnt vmcnt(5)
    buffer_load_dwordx4 v[124:127], v2, s[8:11], s49 offen offset:2176 nt
    s_add_u32 s49, s49, 0x200000
    s_waitcnt vmcnt(5)
    buffer_load_dwordx4 v[128:131], v2, s[8:11], s49 offen offset:0 nt
    s_waitcnt vmcnt(5)
    buffer_load_dwordx4 v[132:135], v2, s[8:11], s49 offen offset:128 nt
    s_waitcnt vmcnt(5)
    buffer_load_dwordx4 v[136:139], v2, s[8:11], s49 offen offset:2048 nt
    s_waitcnt vmcnt(5)
    buffer_load_dwordx4 v[140:143], v2, s[8:11], s49 offen offset:2176 nt
    s_add_u32 s49, s49, 0x200000
    s_waitcnt vmcnt(5)
    buffer_load_dwordx4 v[144:147], v2, s[8:11], s49 offen offset:0 nt
    s_waitcnt vmcnt(5)
    buffer_load_dwordx4 v[148:151], v2, s[8:11], s49 offen offset:128 nt
    s_waitcnt vmcnt(5)
    buffer_load_dwordx4 v[152:155], v2, s[8:11], s49 offen offset:2048 nt
    s_lshl_b32 s6, s4, 3
    s_add_u32 s6, s6, s3
    s_lshl_b32 s63, s6, 12
    s_add_u32 s63, s63, 65536
    s_waitcnt vmcnt(5)
    buffer_load_dwordx4 v[16:19], v3, s[16:19], s63 offen offset:0 sc1
    s_waitcnt vmcnt(5)
    buffer_load_dwordx4 v[20:23], v3, s[16:19], s63 offen offset:1024 sc1
    s_waitcnt vmcnt(5)
    buffer_load_dwordx4 v[24:27], v3, s[16:19], s63 offen offset:2048 sc1
    s_waitcnt vmcnt(5)
    buffer_load_dwordx4 v[28:31], v3, s[16:19], s63 offen offset:3072 sc1
    s_waitcnt vmcnt(5)
    buffer_load_dwordx4 v[156:159], v2, s[8:11], s49 offen offset:2176 nt
    s_add_u32 s49, s49, 0x200000
    s_waitcnt vmcnt(5)
    buffer_load_dwordx4 v[160:163], v2, s[8:11], s49 offen offset:0 nt
    s_waitcnt vmcnt(5)
    buffer_load_dwordx4 v[164:167], v2, s[8:11], s49 offen offset:128 nt
    s_waitcnt vmcnt(5)
    buffer_load_dwordx4 v[168:171], v2, s[8:11], s49 offen offset:2048 nt
    s_waitcnt vmcnt(5)
    buffer_load_dwordx4 v[172:175], v2, s[8:11], s49 offen offset:2176 nt
    s_add_u32 s49, s49, 0x200000
    s_waitcnt vmcnt(5)
    buffer_load_dwordx4 v[176:179], v2, s[8:11], s49 offen offset:0 nt
    s_waitcnt vmcnt(5)
    buffer_load_dwordx4 v[180:183], v2, s[8:11], s49 offen offset:128 nt
    s_mov_b32 s62, 0
L_pollc0:
    v_xor_b32 v14, s48, v16
    v_bitop3_b32 v14, v17, s48, v14 bitop3:0xbe
    v_bitop3_b32 v14, v18, s48, v14 bitop3:0xbe
    v_bitop3_b32 v14, v19, s48, v14 bitop3:0xbe
    v_bitop3_b32 v14, v20, s48, v14 bitop3:0xbe
    v_bitop3_b32 v14, v21, s48, v14 bitop3:0xbe
    v_bitop3_b32 v14, v22, s48, v14 bitop3:0xbe
    v_bitop3_b32 v14, v23, s48, v14 bitop3:0xbe
    v_bitop3_b32 v14, v24, s48, v14 bitop3:0xbe
    v_bitop3_b32 v14, v25, s48, v14 bitop3:0xbe
    v_bitop3_b32 v14, v26, s48, v14 bitop3:0xbe
    v_bitop3_b32 v14, v27, s48, v14 bitop3:0xbe
    v_bitop3_b32 v14, v28, s48, v14 bitop3:0xbe
    v_bitop3_b32 v14, v29, s48, v14 bitop3:0xbe
    v_bitop3_b32 v14, v30, s48, v14 bitop3:0xbe
    v_bitop3_b32 v14, v31, s48, v14 bitop3:0xbe
    s_nop 1
    v_or_b32_dpp v14, v14, v14 quad_perm:[1,0,3,2] row_mask:0xf bank_mask:0xf
    v_and_b32 v14, 3, v14
    v_cmp_ne_u32 vcc, 0, v14
    s_nop 0
    s_mov_b64 exec, vcc
    s_cbranch_execz L_polld0
    s_add_u32 s62, s62, 1
    s_cmp_gt_u32 s62, 0x80000
    s_cbranch_scc1 L_end
    buffer_load_dwordx4 v[16:19], v3, s[16:19], s63 offen offset:0 sc1
    buffer_load_dwordx4 v[20:23], v3, s[16:19], s63 offen offset:1024 sc1
    buffer_load_dwordx4 v[24:27], v3, s[16:19], s63 offen offset:2048 sc1
    buffer_load_dwordx4 v[28:31], v3, s[16:19], s63 offen offset:3072 sc1
    s_waitcnt vmcnt(0)
    s_branch L_pollc0
L_polld0:
    s_mov_b64 exec, -1
    v_and_b32 v16, -4, v16
    v_and_b32 v17, -4, v17
    v_and_b32 v18, -4, v18
    v_and_b32 v19, -4, v19
    v_and_b32 v20, -4, v20
    v_and_b32 v21, -4, v21
    v_and_b32 v22, -4, v22
    v_and_b32 v23, -4, v23
    v_and_b32 v24, -4, v24
    v_and_b32 v25, -4, v25
    v_and_b32 v26, -4, v26
    v_and_b32 v27, -4, v27
    v_and_b32 v28, -4, v28
    v_and_b32 v29, -4, v29
    v_and_b32 v30, -4, v30
    v_and_b32 v31, -4, v31
    v_add_f32 v16, v16, v20
    v_add_f32 v24, v24, v28
    v_add_f32 v17, v17, v21
    v_add_f32 v25, v25, v29
    v_add_f32 v18, v18, v22
    v_add_f32 v26, v26, v30
    v_add_f32 v19, v19, v23
    v_add_f32 v27, v27, v31
    v_add_f32 v16, v16, v24
    v_add_f32 v17, v17, v25
    v_add_f32 v18, v18, v26
    v_add_f32 v19, v19, v27
    v_mov_b32 v20, v16
    v_mov_b32 v21, v17
    v_mov_b32 v22, v18
    v_mov_b32 v23, v19
    v_permlane32_swap_b32 v20, v16
    v_permlane32_swap_b32 v21, v17
    v_permlane32_swap_b32 v22, v18
    v_permlane32_swap_b32 v23, v19
    v_add_f32 v16, v16, v20
    v_add_f32 v17, v17, v21
    v_add_f32 v18, v18, v22
    v_add_f32 v19, v19, v23
    v_cvt_pk_bf16_f32 v24, v16, v17
    v_cvt_pk_bf16_f32 v25, v18, v19
    v_and_b32 v8, 31, v1
    v_lshlrev_b32 v8, 3, v8
    s_lshl_b32 s6, s3, 8
    v_add_u32 v8, s6, v8
    ds_write_b64 v8, v[24:25] offset:4096
    s_waitcnt lgkmcnt(0)
    s_barrier
    v_and_b32 v8, 7, v1
    v_lshlrev_b32 v8, 8, v8
    v_lshrrev_b32 v9, 4, v1
    v_lshl_add_u32 v8, v9, 5, v8
    v_bfe_u32 v9, v1, 3, 1
    v_lshl_add_u32 v8, v9, 4, v8
    ds_read_b128 v[240:243], v8 offset:4096
    ds_read_b128 v[244:247], v8 offset:4224
    s_waitcnt vmcnt(5)
    buffer_load_dwordx4 v[184:187], v2, s[8:11], s49 offen offset:2048 nt
    s_waitcnt vmcnt(5)
    buffer_load_dwordx4 v[188:191], v2, s[8:11], s49 offen offset:2176 nt
    s_add_u32 s49, s49, 0x200000
    v_lshrrev_b32 v9, 4, v1
    v_and_b32 v8, 15, v1
    v_lshlrev_b32 v8, 4, v8
    v_lshl_add_u32 v12, v9, 13, v8
    v_mul_u32_u24 v9, 28672, v9
    v_add_u32 v13, v9, v8
    s_lshl_b32 s64, s90, 17
    s_lshr_b32 s6, s3, 1
    s_lshl_b32 s6, s6, 15
    s_add_u32 s64, s64, s6
    s_lshl_b32 s6, s91, 9
    s_add_u32 s64, s64, s6
    s_and_b32 s6, s3, 1
    s_lshl_b32 s6, s6, 8
    s_add_u32 s64, s64, s6
    s_mov_b32 s66, s64
    s_mul_i32 s69, s91, 7
    s_add_u32 s69, s69, s3
    s_mul_i32 s65, s90, 114688
    s_lshl_b32 s6, s69, 8
    s_add_u32 s65, s65, s6
    s_cmp_eq_u32 s3, 7
    s_cselect_b32 s65, 0x7000000, s65
    s_waitcnt vmcnt(5)
    buffer_load_dwordx4 v[192:195], v12, s[28:31], s64 offen nt
    s_add_u32 s64, s64, 2048
    s_waitcnt vmcnt(5)
    buffer_load_dwordx4 v[196:199], v12, s[28:31], s64 offen nt
    s_add_u32 s64, s64, 2048
    s_waitcnt vmcnt(5)
    buffer_load_dwordx4 v[200:203], v12, s[28:31], s64 offen nt
    s_add_u32 s64, s64, 2048
    s_waitcnt vmcnt(5)
    buffer_load_dwordx4 v[204:207], v12, s[28:31], s64 offen nt
    s_waitcnt vmcnt(5)
    buffer_load_dwordx4 v[208:211], v3, s[12:15], s50 offen offset:0 nt
    s_waitcnt vmcnt(5)
    buffer_load_dwordx4 v[212:215], v3, s[12:15], s50 offen offset:1024 nt
    s_waitcnt lgkmcnt(0)
    v_mfma_f32_16x16x32_bf16 v[32:35], v[64:67], v[240:243], 0
    v_mfma_f32_16x16x32_bf16 v[36:39], v[72:75], v[240:243], 0
    v_mfma_f32_16x16x32_bf16 v[40:43], v[80:83], v[240:243], 0
    v_mfma_f32_16x16x32_bf16 v[44:47], v[88:91], v[240:243], 0
    v_mfma_f32_16x16x32_bf16 v[48:51], v[96:99], v[240:243], 0
    v_mfma_f32_16x16x32_bf16 v[52:55], v[104:107], v[240:243], 0
    v_mfma_f32_16x16x32_bf16 v[56:59], v[112:115], v[240:243], 0
    v_mfma_f32_16x16x32_bf16 v[60:63], v[120:123], v[240:243], 0
    v_mfma_f32_16x16x32_bf16 v[32:35], v[68:71], v[244:247], v[32:35]
    v_mfma_f32_16x16x32_bf16 v[36:39], v[76:79], v[244:247], v[36:39]
    v_mfma_f32_16x16x32_bf16 v[40:43], v[84:87], v[244:247], v[40:43]
    v_mfma_f32_16x16x32_bf16 v[44:47], v[92:95], v[244:247], v[44:47]
    v_mfma_f32_16x16x32_bf16 v[48:51], v[100:103], v[244:247], v[48:51]
    v_mfma_f32_16x16x32_bf16 v[52:55], v[108:111], v[244:247], v[52:55]
    v_mfma_f32_16x16x32_bf16 v[56:59], v[116:119], v[244:247], v[56:59]
    v_mfma_f32_16x16x32_bf16 v[60:63], v[124:127], v[244:247], v[60:63]
    s_nop 0
    v_add_f32_dpp v16, v33, v32 row_ror:8 row_mask:0xf bank_mask:0x3
    v_add_f32_dpp v17, v37, v36 row_ror:8 row_mask:0xf bank_mask:0x3
    v_add_f32_dpp v18, v41, v40 row_ror:8 row_mask:0xf bank_mask:0x3
    v_add_f32_dpp v19, v45, v44 row_ror:8 row_mask:0xf bank_mask:0x3
    v_add_f32_dpp v20, v49, v48 row_ror:8 row_mask:0xf bank_mask:0x3
    v_add_f32_dpp v21, v53, v52 row_ror:8 row_mask:0xf bank_mask:0x3
    v_add_f32_dpp v22, v57, v56 row_ror:8 row_mask:0xf bank_mask:0x3
    v_add_f32_dpp v23, v61, v60 row_ror:8 row_mask:0xf bank_mask:0x3
    v_add_f32_dpp v16, v34, v35 row_ror:8 row_mask:0xf bank_mask:0xc
    v_add_f32_dpp v17, v38, v39 row_ror:8 row_mask:0xf bank_mask:0xc
    v_add_f32_dpp v18, v42, v43 row_ror:8 row_mask:0xf bank_mask:0xc
    v_add_f32_dpp v19, v46, v47 row_ror:8 row_mask:0xf bank_mask:0xc
    v_add_f32_dpp v20, v50, v51 row_ror:8 row_mask:0xf bank_mask:0xc
    v_add_f32_dpp v21, v54, v55 row_ror:8 row_mask:0xf bank_mask:0xc
    v_add_f32_dpp v22, v58, v59 row_ror:8 row_mask:0xf bank_mask:0xc
    v_add_f32_dpp v23, v62, v63 row_ror:8 row_mask:0xf bank_mask:0xc
    buffer_load_dwordx4 v[216:219], v3, s[12:15], s50 offen offset:2048 nt
    v_mfma_f32_16x16x32_bf16 v[32:35], v[128:131], v[240:243], 0
    v_mfma_f32_16x16x32_bf16 v[36:39], v[136:139], v[240:243], 0
    v_mfma_f32_16x16x32_bf16 v[40:43], v[144:147], v[240:243], 0
    v_mfma_f32_16x16x32_bf16 v[44:47], v[152:155], v[240:243], 0
    v_mfma_f32_16x16x32_bf16 v[48:51], v[160:163], v[240:243], 0
    v_mfma_f32_16x16x32_bf16 v[52:55], v[168:171], v[240:243], 0
    v_mfma_f32_16x16x32_bf16 v[56:59], v[176:179], v[240:243], 0
    v_mfma_f32_16x16x32_bf16 v[60:63], v[184:187], v[240:243], 0
    v_mfma_f32_16x16x32_bf16 v[32:35], v[132:135], v[244:247], v[32:35]
    v_mfma_f32_16x16x32_bf16 v[36:39], v[140:143], v[244:247], v[36:39]
    v_mfma_f32_16x16x32_bf16 v[40:43], v[148:151], v[244:247], v[40:43]
    v_mfma_f32_16x16x32_bf16 v[44:47], v[156:159], v[244:247], v[44:47]
    v_mfma_f32_16x16x32_bf16 v[48:51], v[164:167], v[244:247], v[48:51]
    v_mfma_f32_16x16x32_bf16 v[52:55], v[172:175], v[244:247], v[52:55]
    v_mfma_f32_16x16x32_bf16 v[56:59], v[180:183], v[244:247], v[56:59]
    v_mfma_f32_16x16x32_bf16 v[60:63], v[188:191], v[244:247], v[60:63]
    s_nop 0
    v_add_f32_dpp v24, v33, v32 row_ror:8 row_mask:0xf bank_mask:0x3
    v_add_f32_dpp v25, v37, v36 row_ror:8 row_mask:0xf bank_mask:0x3
    v_add_f32_dpp v26, v41, v40 row_ror:8 row_mask:0xf bank_mask:0x3
    v_add_f32_dpp v27, v45, v44 row_ror:8 row_mask:0xf bank_mask:0x3
    v_add_f32_dpp v28, v49, v48 row_ror:8 row_mask:0xf bank_mask:0x3
    v_add_f32_dpp v29, v53, v52 row_ror:8 row_mask:0xf bank_mask:0x3
    v_add_f32_dpp v30, v57, v56 row_ror:8 row_mask:0xf bank_mask:0x3
    v_add_f32_dpp v31, v61, v60 row_ror:8 row_mask:0xf bank_mask:0x3
    v_add_f32_dpp v24, v34, v35 row_ror:8 row_mask:0xf bank_mask:0xc
    v_add_f32_dpp v25, v38, v39 row_ror:8 row_mask:0xf bank_mask:0xc
    v_add_f32_dpp v26, v42, v43 row_ror:8 row_mask:0xf bank_mask:0xc
    v_add_f32_dpp v27, v46, v47 row_ror:8 row_mask:0xf bank_mask:0xc
    v_add_f32_dpp v28, v50, v51 row_ror:8 row_mask:0xf bank_mask:0xc
    v_add_f32_dpp v29, v54, v55 row_ror:8 row_mask:0xf bank_mask:0xc
    v_add_f32_dpp v30, v58, v59 row_ror:8 row_mask:0xf bank_mask:0xc
    v_add_f32_dpp v31, v62, v63 row_ror:8 row_mask:0xf bank_mask:0xc
    buffer_load_dwordx4 v[220:223], v3, s[12:15], s50 offen offset:3072 nt
    s_add_u32 s50, s50, 0x200000
    v_cvt_pk_bf16_f32 v8, v16, v17
    v_lshlrev_b32 v16, 16, v8
    v_and_b32 v17, s56, v8
    v_mul_f32 v16, s57, v16
    v_mul_f32 v17, s57, v17
    v_cvt_pk_bf16_f32 v8, v16, v17
    v_lshlrev_b32 v16, 16, v8
    v_and_b32 v17, s56, v8
    v_cvt_pk_bf16_f32 v8, v18, v19
    v_lshlrev_b32 v18, 16, v8
    v_and_b32 v19, s56, v8
    v_mul_f32 v18, s57, v18
    v_mul_f32 v19, s57, v19
    v_cvt_pk_bf16_f32 v8, v18, v19
    v_lshlrev_b32 v18, 16, v8
    v_and_b32 v19, s56, v8
    v_cvt_pk_bf16_f32 v8, v20, v21
    v_lshlrev_b32 v20, 16, v8
    v_and_b32 v21, s56, v8
    v_mul_f32 v20, s57, v20
    v_mul_f32 v21, s57, v21
    v_cvt_pk_bf16_f32 v8, v20, v21
    v_lshlrev_b32 v20, 16, v8
    v_and_b32 v21, s56, v8
    v_cvt_pk_bf16_f32 v8, v22, v23
    v_lshlrev_b32 v22, 16, v8
    v_and_b32 v23, s56, v8
    v_mul_f32 v22, s57, v22
    v_mul_f32 v23, s57, v23
    v_cvt_pk_bf16_f32 v8, v22, v23
    v_lshlrev_b32 v22, 16, v8
    v_and_b32 v23, s56, v8
    v_cvt_pk_bf16_f32 v8, v24, v25
    v_lshlrev_b32 v24, 16, v8
    v_and_b32 v25, s56, v8
    v_mul_f32 v24, s57, v24
    v_mul_f32 v25, s57, v25
    v_cvt_pk_bf16_f32 v8, v24, v25
    v_lshlrev_b32 v24, 16, v8
    v_and_b32 v25, s56, v8
    v_cvt_pk_bf16_f32 v8, v26, v27
    v_lshlrev_b32 v26, 16, v8
    v_and_b32 v27, s56, v8
    v_mul_f32 v26, s57, v26
    v_mul_f32 v27, s57, v27
    v_cvt_pk_bf16_f32 v8, v26, v27
    v_lshlrev_b32 v26, 16, v8
    v_and_b32 v27, s56, v8
    v_cvt_pk_bf16_f32 v8, v28, v29
    v_lshlrev_b32 v28, 16, v8
    v_and_b32 v29, s56, v8
    v_mul_f32 v28, s57, v28
    v_mul_f32 v29, s57, v29
    v_cvt_pk_bf16_f32 v8, v28, v29
    v_lshlrev_b32 v28, 16, v8
    v_and_b32 v29, s56, v8
    v_cvt_pk_bf16_f32 v8, v30, v31
    v_lshlrev_b32 v30, 16, v8
    v_and_b32 v31, s56, v8
    v_mul_f32 v30, s57, v30
    v_mul_f32 v31, s57, v31
    v_cvt_pk_bf16_f32 v8, v30, v31
    v_lshlrev_b32 v30, 16, v8
    v_and_b32 v31, s56, v8
    v_max3_f32 v5, v16, v17, v18
    v_max3_f32 v5, v5, v19, v20
    v_max3_f32 v5, v5, v21, v22
    v_max3_f32 v5, v5, v23, v24
    v_max3_f32 v5, v5, v25, v26
    v_max3_f32 v5, v5, v27, v28
    v_max3_f32 v5, v5, v29, v30
    v_max_f32 v5, v5, v31
    v_mov_b32 v8, v5
    s_nop 1
    v_permlane32_swap_b32 v8, v5
    v_max_f32 v5, v5, v8
    v_mov_b32 v8, v5
    s_nop 1
    v_permlane16_swap_b32 v8, v5
    v_max_f32 v5, v5, v8
    s_nop 1
    v_max_f32_dpp v5, v5, v5 row_ror:8 row_mask:0xf bank_mask:0xf
    buffer_load_dwordx4 v[224:227], v3, s[12:15], s50 offen offset:0 nt
    v_sub_f32 v16, v16, v5
    v_sub_f32 v17, v17, v5
    v_sub_f32 v18, v18, v5
    v_sub_f32 v19, v19, v5
    v_sub_f32 v20, v20, v5
    v_sub_f32 v21, v21, v5
    v_sub_f32 v22, v22, v5
    v_sub_f32 v23, v23, v5
    v_sub_f32 v24, v24, v5
    v_sub_f32 v25, v25, v5
    v_sub_f32 v26, v26, v5
    v_sub_f32 v27, v27, v5
    v_sub_f32 v28, v28, v5
    v_sub_f32 v29, v29, v5
    v_sub_f32 v30, v30, v5
    v_sub_f32 v31, v31, v5
    v_mul_f32 v16, s58, v16
    v_mul_f32 v17, s58, v17
    v_mul_f32 v18, s58, v18
    v_mul_f32 v19, s58, v19
    v_mul_f32 v20, s58, v20
    v_mul_f32 v21, s58, v21
    v_mul_f32 v22, s58, v22
    v_mul_f32 v23, s58, v23
    v_mul_f32 v24, s58, v24
    v_mul_f32 v25, s58, v25
    v_mul_f32 v26, s58, v26
    v_mul_f32 v27, s58, v27
    v_mul_f32 v28, s58, v28
    v_mul_f32 v29, s58, v29
    v_mul_f32 v30, s58, v30
    v_mul_f32 v31, s58, v31
    v_exp_f32 v16, v16
    v_exp_f32 v17, v17
    v_exp_f32 v18, v18
    v_exp_f32 v19, v19
    v_exp_f32 v20, v20
    v_exp_f32 v21, v21
    v_exp_f32 v22, v22
    v_exp_f32 v23, v23
    v_exp_f32 v24, v24
    v_exp_f32 v25, v25
    v_exp_f32 v26, v26
    v_exp_f32 v27, v27
    v_exp_f32 v28, v28
    v_exp_f32 v29, v29
    v_exp_f32 v30, v30
    v_exp_f32 v31, v31
    v_add_f32 v11, v16, v17
    v_add_f32 v11, v11, v18
    v_add_f32 v11, v11, v19
    v_add_f32 v11, v11, v20
    v_add_f32 v11, v11, v21
    v_add_f32 v11, v11, v22
    v_add_f32 v11, v11, v23
    v_add_f32 v11, v11, v24
    v_add_f32 v11, v11, v25
    v_add_f32 v11, v11, v26
    v_add_f32 v11, v11, v27
    v_add_f32 v11, v11, v28
    v_add_f32 v11, v11, v29
    v_add_f32 v11, v11, v30
    v_add_f32 v11, v11, v31
    v_mov_b32 v8, v11
    s_nop 1
    v_permlane32_swap_b32 v8, v11
    v_add_f32 v11, v11, v8
    v_mov_b32 v8, v11
    s_nop 1
    v_permlane16_swap_b32 v8, v11
    v_add_f32 v11, v11, v8
    s_nop 1
    v_add_f32_dpp v11, v11, v11 row_ror:8 row_mask:0xf bank_mask:0xf
    v_mov_b32 v10, v5
    v_and_b32 v8, 7, v1
    v_lshlrev_b32 v8, 3, v8
    s_lshl_b32 s6, s3, 6
    v_add_u32 v8, s6, v8
    ds_write_b64 v8, v[10:11] offset:6144
    buffer_load_dwordx4 v[228:231], v3, s[12:15], s50 offen offset:1024 nt
    s_waitcnt lgkmcnt(0)
    s_barrier
    buffer_load_dwordx4 v[232:235], v3, s[12:15], s50 offen offset:2048 nt
    s_cmp_lg_u32 s3, 0
    s_cbranch_scc1 L_noml
    v_lshlrev_b32 v8, 3, v1
    ds_read_b64 v[10:11], v8 offset:6144
    s_waitcnt lgkmcnt(0)
    v_mov_b32 v9, v10
    v_mov_b32 v8, v9
    s_nop 1
    v_permlane32_swap_b32 v8, v9
    v_max_f32 v9, v9, v8
    v_mov_b32 v8, v9
    s_nop 1
    v_permlane16_swap_b32 v8, v9
    v_max_f32 v9, v9, v8
    s_nop 1
    v_max_f32_dpp v9, v9, v9 row_ror:8 row_mask:0xf bank_mask:0xf
    v_sub_f32 v10, v10, v9
    v_mul_f32 v10, s58, v10
    v_exp_f32 v10, v10
    s_nop 0
    v_mul_f32 v11, v11, v10
    v_mov_b32 v8, v11
    s_nop 1
    v_permlane32_swap_b32 v8, v11
    v_add_f32 v11, v11, v8
    v_mov_b32 v8, v11
    s_nop 1
    v_permlane16_swap_b32 v8, v11
    v_add_f32 v11, v11, v8
    s_nop 1
    v_add_f32_dpp v11, v11, v11 row_ror:8 row_mask:0xf bank_mask:0xf
    v_or_b32 v10, s52, v9
    v_and_or_b32 v11, v11, v4, s51
    v_lshlrev_b32 v8, 9, v1
    s_lshl_b32 s6, s4, 12
    s_lshl_b32 s7, s5, 3
    s_add_u32 s6, s6, s7
    s_add_u32 s6, s6, 262144
    s_mov_b64 exec, 0xff
    buffer_store_dwordx2 v[10:11], v8, s[16:19], s6 offen sc1
    s_mov_b64 exec, -1
L_noml:
    v_lshrrev_b32 v14, 4, v1
    v_lshlrev_b32 v14, 4, v14
    v_and_b32 v8, 3, v1
    v_lshl_add_u32 v2, v8, 6, v14
    v_and_b32 v8, 7, v1
    v_lshl_add_u32 v6, v8, 6, v14
    s_lshl_b32 s72, s90, 11
    s_lshr_b32 s6, s3, 1
    s_lshl_b32 s6, s6, 9
    s_add_u32 s72, s72, s6
    s_add_u32 s72, s72, 327680
    s_waitcnt vmcnt(5)
    buffer_load_dwordx4 v[236:239], v3, s[12:15], s50 offen offset:3072 nt
    s_add_u32 s50, s50, 0x200000
    v_mov_b32 v8, 0x3f803f80
    v_mov_b32 v32, 0
    v_mov_b32 v33, 0
    v_mov_b32 v34, 0
    v_mov_b32 v35, 0
    v_dot2_f32_bf16 v32, v192, v8, v32
    v_dot2_f32_bf16 v33, v196, v8, v33
    v_dot2_f32_bf16 v34, v200, v8, v34
    v_dot2_f32_bf16 v35, v204, v8, v35
    v_dot2_f32_bf16 v32, v193, v8, v32
    v_dot2_f32_bf16 v33, v197, v8, v33
    v_dot2_f32_bf16 v34, v201, v8, v34
    v_dot2_f32_bf16 v35, v205, v8, v35
    v_dot2_f32_bf16 v32, v194, v8, v32
    v_dot2_f32_bf16 v33, v198, v8, v33
    v_dot2_f32_bf16 v34, v202, v8, v34
    v_dot2_f32_bf16 v35, v206, v8, v35
    v_dot2_f32_bf16 v32, v195, v8, v32
    v_dot2_f32_bf16 v33, v199, v8, v33
    v_dot2_f32_bf16 v34, v203, v8, v34
    v_dot2_f32_bf16 v35, v207, v8, v35
    v_add_f32_dpp v32, v32, v32 row_ror:8 row_mask:0xf bank_mask:0xf
    v_add_f32_dpp v33, v33, v33 row_ror:8 row_mask:0xf bank_mask:0xf
    v_add_f32_dpp v34, v34, v34 row_ror:8 row_mask:0xf bank_mask:0xf
    v_add_f32_dpp v35, v35, v35 row_ror:8 row_mask:0xf bank_mask:0xf
    v_add_f32_dpp v32, v32, v32 row_ror:4 row_mask:0xf bank_mask:0xf
    v_add_f32_dpp v33, v33, v33 row_ror:4 row_mask:0xf bank_mask:0xf
    v_add_f32_dpp v34, v34, v34 row_ror:4 row_mask:0xf bank_mask:0xf
    v_add_f32_dpp v35, v35, v35 row_ror:4 row_mask:0xf bank_mask:0xf
    v_add_f32_dpp v32, v32, v32 row_ror:2 row_mask:0xf bank_mask:0xf
    v_add_f32_dpp v33, v33, v33 row_ror:2 row_mask:0xf bank_mask:0xf
    v_add_f32_dpp v34, v34, v34 row_ror:2 row_mask:0xf bank_mask:0xf
    v_add_f32_dpp v35, v35, v35 row_ror:2 row_mask:0xf bank_mask:0xf
    v_add_f32_dpp v32, v32, v32 row_ror:1 row_mask:0xf bank_mask:0xf
    v_add_f32_dpp v33, v33, v33 row_ror:1 row_mask:0xf bank_mask:0xf
    v_add_f32_dpp v34, v34, v34 row_ror:1 row_mask:0xf bank_mask:0xf
    v_add_f32_dpp v35, v35, v35 row_ror:1 row_mask:0xf bank_mask:0xf
    v_and_or_b32 v32, v32, v4, s51
    v_and_or_b32 v33, v33, v4, s51
    v_and_or_b32 v34, v34, v4, s51
    v_and_or_b32 v35, v35, v4, s51
    s_lshl_b32 s6, s91, 1
    s_and_b32 s7, s3, 1
    s_add_u32 s6, s6, s7
    s_lshl_b32 s6, s6, 6
    s_add_u32 s6, s6, s72
    s_mov_b32 exec_lo, 0x10001
    s_mov_b32 exec_hi, 0x10001
    s_waitcnt vmcnt(5)
    buffer_store_dwordx4 v[32:35], v2, s[16:19], s6 offen sc1
    s_mov_b64 exec, -1
    s_waitcnt vmcnt(5)
    buffer_load_dwordx4 v[64:67], v3, s[12:15], s50 offen offset:0 nt
    s_waitcnt vmcnt(5)
    buffer_load_dwordx4 v[68:71], v3, s[12:15], s50 offen offset:1024 nt
    s_waitcnt vmcnt(5)
    buffer_load_dwordx4 v[72:75], v3, s[12:15], s50 offen offset:2048 nt
    s_waitcnt vmcnt(5)
    buffer_load_dwordx4 v[76:79], v3, s[12:15], s50 offen offset:3072 nt
    s_add_u32 s50, s50, 0x200000
    s_waitcnt vmcnt(5)
    buffer_load_dwordx4 v[80:83], v3, s[12:15], s50 offen offset:0 nt
    s_waitcnt vmcnt(5)
    buffer_load_dwordx4 v[84:87], v3, s[12:15], s50 offen offset:1024 nt
    s_waitcnt vmcnt(5)
    buffer_load_dwordx4 v[88:91], v3, s[12:15], s50 offen offset:2048 nt
    s_waitcnt vmcnt(5)
    buffer_load_dwordx4 v[92:95], v3, s[12:15], s50 offen offset:3072 nt
    s_add_u32 s50, s50, 0x200000
    s_waitcnt vmcnt(5)
    buffer_load_dwordx4 v[96:99], v3, s[12:15], s50 offen offset:0 nt
    v_lshlrev_b32 v8, 3, v1
    s_lshl_b32 s6, s4, 3
    s_add_u32 s6, s6, s3
    s_lshl_b32 s70, s6, 9
    s_add_u32 s70, s70, 262144
    s_waitcnt vmcnt(5)
    buffer_load_dwordx2 v[10:11], v8, s[16:19], s70 offen sc1
    s_waitcnt vmcnt(5)
    buffer_load_dwordx4 v[100:103], v3, s[12:15], s50 offen offset:1024 nt
    s_waitcnt vmcnt(5)
    buffer_load_dwordx4 v[104:107], v3, s[12:15], s50 offen offset:2048 nt
    s_waitcnt vmcnt(5)
    buffer_load_dwordx4 v[108:111], v3, s[12:15], s50 offen offset:3072 nt
    s_add_u32 s50, s50, 0x200000
    s_waitcnt vmcnt(5)
    buffer_load_dwordx4 v[112:115], v3, s[12:15], s50 offen offset:0 nt
    s_waitcnt vmcnt(5)
    buffer_load_dwordx4 v[116:119], v3, s[12:15], s50 offen offset:1024 nt
    s_waitcnt vmcnt(5)
    buffer_load_dwordx4 v[120:123], v3, s[12:15], s50 offen offset:2048 nt
    v_xor_b32 v14, s52, v10
    v_and_b32 v14, 0xffff, v14
    v_xor_b32 v9, s51, v11
    v_and_b32 v9, 0xff, v9
    v_or_b32 v14, v14, v9
    v_cmp_ne_u32 vcc, 0, v14
    s_cbranch_vccz L_mlok
    s_mov_b32 s62, 0
L_mlspin:
    buffer_load_dwordx2 v[10:11], v8, s[16:19], s70 offen sc1
    s_waitcnt vmcnt(0)
    s_add_u32 s62, s62, 1
    s_cmp_gt_u32 s62, 0x80000
    s_cbranch_scc1 L_end
    v_xor_b32 v14, s52, v10
    v_and_b32 v14, 0xffff, v14
    v_xor_b32 v9, s51, v11
    v_and_b32 v9, 0xff, v9
    v_or_b32 v14, v14, v9
    v_cmp_ne_u32 vcc, 0, v14
    s_cbranch_vccnz L_mlspin
L_mlok:
    v_and_b32 v10, s56, v10
    v_and_or_b32 v11, v11, v4, s59
    v_mov_b32 v9, v10
    v_mov_b32 v8, v9
    s_nop 1
    v_permlane32_swap_b32 v8, v9
    v_max_f32 v9, v9, v8
    v_mov_b32 v8, v9
    s_nop 1
    v_permlane16_swap_b32 v8, v9
    v_max_f32 v9, v9, v8
    s_nop 1
    v_max_f32_dpp v9, v9, v9 row_ror:8 row_mask:0xf bank_mask:0xf
    s_nop 1
    v_max_f32_dpp v9, v9, v9 row_ror:4 row_mask:0xf bank_mask:0xf
    s_nop 1
    v_max_f32_dpp v9, v9, v9 row_ror:2 row_mask:0xf bank_mask:0xf
    s_nop 1
    v_max_f32_dpp v9, v9, v9 row_ror:1 row_mask:0xf bank_mask:0xf
    v_sub_f32 v10, v10, v9
    v_mul_f32 v10, s58, v10
    v_exp_f32 v10, v10
    s_nop 0
    v_mul_f32 v11, v11, v10
    v_mov_b32 v8, v11
    s_nop 1
    v_permlane32_swap_b32 v8, v11
    v_add_f32 v11, v11, v8
    v_mov_b32 v8, v11
    s_nop 1
    v_permlane16_swap_b32 v8, v11
    v_add_f32 v11, v11, v8
    s_nop 1
    v_add_f32_dpp v11, v11, v11 row_ror:8 row_mask:0xf bank_mask:0xf
    s_nop 1
    v_add_f32_dpp v11, v11, v11 row_ror:4 row_mask:0xf bank_mask:0xf
    s_nop 1
    v_add_f32_dpp v11, v11, v11 row_ror:2 row_mask:0xf bank_mask:0xf
    s_nop 1
    v_add_f32_dpp v11, v11, v11 row_ror:1 row_mask:0xf bank_mask:0xf
    v_rcp_f32 v11, v11
    v_mov_b32 v10, v9
    s_lshl_b32 s6, s3, 3
    v_mov_b32 v8, s6
    ds_write_b64 v8, v[10:11] offset:6656
    s_waitcnt lgkmcnt(0)
    s_barrier
    v_and_b32 v8, 7, v1
    v_lshlrev_b32 v8, 3, v8
    ds_read_b64 v[10:11], v8 offset:6656
    s_waitcnt lgkmcnt(0)
    v_sub_f32 v10, v5, v10
    v_mul_f32 v10, s58, v10
    v_exp_f32 v10, v10
    s_nop 0
    v_mul_f32 v10, v10, v11
    v_bfe_u32 v9, v1, 3, 1
    v_cmp_eq_u32 vcc, 1, v9
    v_mov_b32 v9, 0xffff
    v_mov_b32 v8, s56
    v_cndmask_b32 v9, v9, v8, vcc
    v_mul_f32 v16, v16, v10
    v_mul_f32 v17, v17, v10
    v_mul_f32 v18, v18, v10
    v_mul_f32 v19, v19, v10
    v_mul_f32 v20, v20, v10
    v_mul_f32 v21, v21, v10
    v_mul_f32 v22, v22, v10
    v_mul_f32 v23, v23, v10
    v_mul_f32 v24, v24, v10
    v_mul_f32 v25, v25, v10
    v_mul_f32 v26, v26, v10
    v_mul_f32 v27, v27, v10
    v_mul_f32 v28, v28, v10
    v_mul_f32 v29, v29, v10
    v_mul_f32 v30, v30, v10
    v_mul_f32 v31, v31, v10
    v_cvt_pk_bf16_f32 v16, v16, v16
    v_cvt_pk_bf16_f32 v17, v17, v17
    v_cvt_pk_bf16_f32 v18, v18, v18
    v_cvt_pk_bf16_f32 v19, v19, v19
    v_cvt_pk_bf16_f32 v20, v20, v20
    v_cvt_pk_bf16_f32 v21, v21, v21
    v_cvt_pk_bf16_f32 v22, v22, v22
    v_cvt_pk_bf16_f32 v23, v23, v23
    v_cvt_pk_bf16_f32 v24, v24, v24
    v_cvt_pk_bf16_f32 v25, v25, v25
    v_cvt_pk_bf16_f32 v26, v26, v26
    v_cvt_pk_bf16_f32 v27, v27, v27
    v_cvt_pk_bf16_f32 v28, v28, v28
    v_cvt_pk_bf16_f32 v29, v29, v29
    v_cvt_pk_bf16_f32 v30, v30, v30
    v_cvt_pk_bf16_f32 v31, v31, v31
    v_and_b32 v16, v16, v9
    v_and_b32 v17, v17, v9
    v_and_b32 v18, v18, v9
    v_and_b32 v19, v19, v9
    v_and_b32 v20, v20, v9
    v_and_b32 v21, v21, v9
    v_and_b32 v22, v22, v9
    v_and_b32 v23, v23, v9
    v_and_b32 v24, v24, v9
    v_and_b32 v25, v25, v9
    v_and_b32 v26, v26, v9
    v_and_b32 v27, v27, v9
    v_and_b32 v28, v28, v9
    v_and_b32 v29, v29, v9
    v_and_b32 v30, v30, v9
    v_and_b32 v31, v31, v9
    v_perm_b32 v240, v212, v208, s54
    v_perm_b32 v241, v220, v216, s54
    v_perm_b32 v242, v228, v224, s54
    v_perm_b32 v243, v236, v232, s54
    v_perm_b32 v244, v212, v208, s55
    v_perm_b32 v245, v220, v216, s55
    v_perm_b32 v246, v228, v224, s55
    v_perm_b32 v247, v236, v232, s55
    v_mfma_f32_16x16x32_bf16 v[32:35], v[16:19], v[240:243], 0
    s_nop 0
    v_mfma_f32_16x16x32_bf16 v[36:39], v[16:19], v[244:247], 0
    v_perm_b32 v248, v213, v209, s54
    v_perm_b32 v249, v221, v217, s54
    v_perm_b32 v250, v229, v225, s54
    v_perm_b32 v251, v237, v233, s54
    v_perm_b32 v252, v213, v209, s55
    v_perm_b32 v253, v221, v217, s55
    v_perm_b32 v254, v229, v225, s55
    v_perm_b32 v255, v237, v233, s55
    v_mfma_f32_16x16x32_bf16 v[40:43], v[16:19], v[248:251], 0
    s_nop 0
    v_mfma_f32_16x16x32_bf16 v[44:47], v[16:19], v[252:255], 0
    v_perm_b32 v240, v214, v210, s54
    v_perm_b32 v241, v222, v218, s54
    v_perm_b32 v242, v230, v226, s54
    v_perm_b32 v243, v238, v234, s54
    v_perm_b32 v244, v214, v210, s55
    v_perm_b32 v245, v222, v218, s55
    v_perm_b32 v246, v230, v226, s55
    v_perm_b32 v247, v238, v234, s55
    v_mfma_f32_16x16x32_bf16 v[48:51], v[16:19], v[240:243], 0
    s_nop 0
    v_mfma_f32_16x16x32_bf16 v[52:55], v[16:19], v[244:247], 0
    v_perm_b32 v248, v215, v211, s54
    v_perm_b32 v249, v223, v219, s54
    v_perm_b32 v250, v231, v227, s54
    v_perm_b32 v251, v239, v235, s54
    v_perm_b32 v252, v215, v211, s55
    v_perm_b32 v253, v223, v219, s55
    v_perm_b32 v254, v231, v227, s55
    v_perm_b32 v255, v239, v235, s55
    v_mfma_f32_16x16x32_bf16 v[56:59], v[16:19], v[248:251], 0
    s_nop 0
    v_mfma_f32_16x16x32_bf16 v[60:63], v[16:19], v[252:255], 0
    v_perm_b32 v240, v68, v64, s54
    v_perm_b32 v241, v76, v72, s54
    v_perm_b32 v242, v84, v80, s54
    v_perm_b32 v243, v92, v88, s54
    v_perm_b32 v244, v68, v64, s55
    v_perm_b32 v245, v76, v72, s55
    v_perm_b32 v246, v84, v80, s55
    v_perm_b32 v247, v92, v88, s55
    v_mfma_f32_16x16x32_bf16 v[32:35], v[20:23], v[240:243], v[32:35]
    s_nop 0
    v_mfma_f32_16x16x32_bf16 v[36:39], v[20:23], v[244:247], v[36:39]
    v_perm_b32 v248, v69, v65, s54
    v_perm_b32 v249, v77, v73, s54
    v_perm_b32 v250, v85, v81, s54
    v_perm_b32 v251, v93, v89, s54
    v_perm_b32 v252, v69, v65, s55
    v_perm_b32 v253, v77, v73, s55
    v_perm_b32 v254, v85, v81, s55
    v_perm_b32 v255, v93, v89, s55
    v_mfma_f32_16x16x32_bf16 v[40:43], v[20:23], v[248:251], v[40:43]
    s_nop 0
    v_mfma_f32_16x16x32_bf16 v[44:47], v[20:23], v[252:255], v[44:47]
    v_perm_b32 v240, v70, v66, s54
    v_perm_b32 v241, v78, v74, s54
    v_perm_b32 v242, v86, v82, s54
    v_perm_b32 v243, v94, v90, s54
    v_perm_b32 v244, v70, v66, s55
    v_perm_b32 v245, v78, v74, s55
    v_perm_b32 v246, v86, v82, s55
    v_perm_b32 v247, v94, v90, s55
    v_mfma_f32_16x16x32_bf16 v[48:51], v[20:23], v[240:243], v[48:51]
    s_nop 0
    v_mfma_f32_16x16x32_bf16 v[52:55], v[20:23], v[244:247], v[52:55]
    v_perm_b32 v248, v71, v67, s54
    v_perm_b32 v249, v79, v75, s54
    v_perm_b32 v250, v87, v83, s54
    v_perm_b32 v251, v95, v91, s54
    v_perm_b32 v252, v71, v67, s55
    v_perm_b32 v253, v79, v75, s55
    v_perm_b32 v254, v87, v83, s55
    v_perm_b32 v255, v95, v91, s55
    v_mfma_f32_16x16x32_bf16 v[56:59], v[20:23], v[248:251], v[56:59]
    s_nop 0
    v_mfma_f32_16x16x32_bf16 v[60:63], v[20:23], v[252:255], v[60:63]
    s_waitcnt vmcnt(5)
    buffer_load_dwordx4 v[208:211], v6, s[16:19], s72 offen sc1
    v_lshrrev_b32 v8, 4, v1
    v_lshlrev_b32 v8, 3, v8
    s_lshl_b32 s6, s90, 5
    s_waitcnt vmcnt(5)
    buffer_load_dwordx2 v[212:213], v8, s[20:23], s6 offen
    s_waitcnt vmcnt(5)
    buffer_load_dwordx4 v[124:127], v3, s[12:15], s50 offen offset:3072 nt
    s_add_u32 s50, s50, 0x200000
    s_waitcnt vmcnt(5)
    buffer_load_dwordx4 v[128:131], v3, s[12:15], s50 offen offset:0 nt
    s_waitcnt vmcnt(5)
    buffer_load_dwordx4 v[132:135], v3, s[12:15], s50 offen offset:1024 nt
    s_waitcnt vmcnt(5)
    buffer_load_dwordx4 v[136:139], v3, s[12:15], s50 offen offset:2048 nt
    s_waitcnt vmcnt(5)
    buffer_load_dwordx4 v[140:143], v3, s[12:15], s50 offen offset:3072 nt
    s_add_u32 s50, s50, 0x200000
    s_waitcnt vmcnt(5)
    buffer_load_dwordx4 v[144:147], v3, s[12:15], s50 offen offset:0 nt
    s_waitcnt vmcnt(5)
    buffer_load_dwordx4 v[148:151], v3, s[12:15], s50 offen offset:1024 nt
    v_perm_b32 v240, v100, v96, s54
    v_perm_b32 v241, v108, v104, s54
    v_perm_b32 v242, v116, v112, s54
    v_perm_b32 v243, v124, v120, s54
    v_perm_b32 v244, v100, v96, s55
    v_perm_b32 v245, v108, v104, s55
    v_perm_b32 v246, v116, v112, s55
    v_perm_b32 v247, v124, v120, s55
    v_mfma_f32_16x16x32_bf16 v[32:35], v[24:27], v[240:243], v[32:35]
    s_nop 0
    v_mfma_f32_16x16x32_bf16 v[36:39], v[24:27], v[244:247], v[36:39]
    v_perm_b32 v248, v101, v97, s54
    v_perm_b32 v249, v109, v105, s54
    v_perm_b32 v250, v117, v113, s54
    v_perm_b32 v251, v125, v121, s54
    v_perm_b32 v252, v101, v97, s55
    v_perm_b32 v253, v109, v105, s55
    v_perm_b32 v254, v117, v113, s55
    v_perm_b32 v255, v125, v121, s55
    v_mfma_f32_16x16x32_bf16 v[40:43], v[24:27], v[248:251], v[40:43]
    s_nop 0
    v_mfma_f32_16x16x32_bf16 v[44:47], v[24:27], v[252:255], v[44:47]
    v_perm_b32 v240, v102, v98, s54
    v_perm_b32 v241, v110, v106, s54
    v_perm_b32 v242, v118, v114, s54
    v_perm_b32 v243, v126, v122, s54
    v_perm_b32 v244, v102, v98, s55
    v_perm_b32 v245, v110, v106, s55
    v_perm_b32 v246, v118, v114, s55
    v_perm_b32 v247, v126, v122, s55
    v_mfma_f32_16x16x32_bf16 v[48:51], v[24:27], v[240:243], v[48:51]
    s_nop 0
    v_mfma_f32_16x16x32_bf16 v[52:55], v[24:27], v[244:247], v[52:55]
    v_perm_b32 v248, v103, v99, s54
    v_perm_b32 v249, v111, v107, s54
    v_perm_b32 v250, v119, v115, s54
    v_perm_b32 v251, v127, v123, s54
    v_perm_b32 v252, v103, v99, s55
    v_perm_b32 v253, v111, v107, s55
    v_perm_b32 v254, v119, v115, s55
    v_perm_b32 v255, v127, v123, s55
    v_mfma_f32_16x16x32_bf16 v[56:59], v[24:27], v[248:251], v[56:59]
    s_nop 0
    v_mfma_f32_16x16x32_bf16 v[60:63], v[24:27], v[252:255], v[60:63]
    s_waitcnt vmcnt(5)
    buffer_load_dwordx4 v[152:155], v3, s[12:15], s50 offen offset:2048 nt
    s_waitcnt vmcnt(5)
    buffer_load_dwordx4 v[156:159], v3, s[12:15], s50 offen offset:3072 nt
    s_add_u32 s50, s50, 0x200000
    v_bfe_u32 v14, v1, 4, 1
    v_lshlrev_b32 v8, 3, v14
    v_lshrrev_b32 v14, 5, v1
    v_lshl_add_u32 v8, v14, 2, v8
    v_and_b32 v14, 3, v1
    v_lshl_add_u32 v9, v14, 4, v8
    v_lshlrev_b32 v9, 2, v9
    s_lshl_b32 s6, s3, 2
    v_add_u32 v9, s6, v9
    v_and_b32 v14, 15, v1
    v_lshl_add_u32 v7, v14, 4, v8
    v_lshlrev_b32 v7, 3, v7
    v_lshrrev_b32 v14, 1, v14
    v_add_u32 v14, s3, v14
    v_and_b32 v14, 7, v14
    v_lshl_add_u32 v7, v14, 2, v7
    v_lshlrev_b32 v214, 2, v1
    v_and_b32 v8, 15, v1
    v_lshlrev_b32 v8, 4, v8
    v_lshrrev_b32 v14, 5, v1
    v_lshl_add_u32 v8, v14, 8, v8
    v_bfe_u32 v14, v1, 4, 1
    v_lshl_add_u32 v8, v14, 9, v8
    s_lshl_b32 s6, s3, 12
    v_add_u32 v10, s6, v8
    v_lshrrev_b32 v8, 5, v1
    v_lshlrev_b32 v8, 3, v8
    v_bfe_u32 v14, v1, 3, 1
    v_add_u32 v8, v8, v14
    v_mul_u32_u24 v8, 16640, v8
    v_and_b32 v14, 7, v1
    v_lshl_add_u32 v8, v14, 5, v8
    v_bfe_u32 v14, v1, 4, 1
    v_lshl_add_u32 v11, v14, 4, v8
    s_mul_i32 s71, s4, 266240
    s_mul_i32 s6, s3, 33280
    s_add_u32 s71, s71, s6
    s_lshl_b32 s6, s5, 8
    s_add_u32 s71, s71, s6
    s_add_u32 s71, s71, 786432
    v_bfe_u32 v8, v1, 3, 1
    v_mul_u32_u24 v8, 16640, v8
    v_and_b32 v14, 7, v1
    v_lshl_add_u32 v8, v14, 5, v8
    v_bfe_u32 v14, v1, 4, 1
    v_lshl_add_u32 v5, v14, 4, v8
    s_mul_i32 s73, s69, 33280
    s_lshl_b32 s6, s90, 8
    s_add_u32 s73, s73, s6
    s_add_u32 s73, s73, 2097152
    s_mul_i32 s74, s90, 16640
    s_lshl_b32 s6, s3, 11
    s_add_u32 s74, s74, s6
    s_mul_i32 s75, s91, 67584
    s_lshl_b32 s6, s90, 6
    s_add_u32 s75, s75, s6
    s_mul_i32 s76, s90, 4224
    s_lshl_b32 s6, s3, 10
    s_add_u32 s76, s76, s6
    s_mov_b32 s79, 0
    s_and_b32 s77, s2, 7
    s_lshl_b32 s77, s77, 10
    s_mov_b32 s62, 0
L_pollc1:
    v_xor_b32 v208, s51, v208
    v_xor_b32 v209, s51, v209
    v_xor_b32 v210, s51, v210
    v_xor_b32 v211, s51, v211
    v_or3_b32 v14, v208, v209, v210
    v_or_b32 v14, v14, v211
    s_nop 1
    v_or_b32_dpp v14, v14, v14 quad_perm:[1,0,3,2] row_mask:0xf bank_mask:0xf
    v_cmp_ne_u32_sdwa vcc, v14, s79 src0_sel:BYTE_0 src1_sel:DWORD
    s_nop 0
    s_mov_b64 exec, vcc
    s_cbranch_execz L_polld1
    s_add_u32 s62, s62, 1
    s_cmp_gt_u32 s62, 0x80000
    s_cbranch_scc1 L_end
    buffer_load_dwordx4 v[208:211], v6, s[16:19], s72 offen offset:0 sc1
    s_waitcnt vmcnt(0)
    s_branch L_pollc1
L_polld1:
    s_mov_b64 exec, -1
    v_add_f32_dpp v208, v208, v208 quad_perm:[1,0,3,2] row_mask:0xf bank_mask:0xf
    v_add_f32_dpp v209, v209, v209 quad_perm:[1,0,3,2] row_mask:0xf bank_mask:0xf
    v_add_f32_dpp v210, v210, v210 quad_perm:[1,0,3,2] row_mask:0xf bank_mask:0xf
    v_add_f32_dpp v211, v211, v211 quad_perm:[1,0,3,2] row_mask:0xf bank_mask:0xf
    v_add_f32_dpp v208, v208, v208 quad_perm:[2,3,0,1] row_mask:0xf bank_mask:0xf
    v_add_f32_dpp v209, v209, v209 quad_perm:[2,3,0,1] row_mask:0xf bank_mask:0xf
    v_add_f32_dpp v210, v210, v210 quad_perm:[2,3,0,1] row_mask:0xf bank_mask:0xf
    v_add_f32_dpp v211, v211, v211 quad_perm:[2,3,0,1] row_mask:0xf bank_mask:0xf
    v_add_f32_dpp v208, v208, v208 row_half_mirror row_mask:0xf bank_mask:0xf
    v_add_f32_dpp v209, v209, v209 row_half_mirror row_mask:0xf bank_mask:0xf
    v_add_f32_dpp v210, v210, v210 row_half_mirror row_mask:0xf bank_mask:0xf
    v_add_f32_dpp v211, v211, v211 row_half_mirror row_mask:0xf bank_mask:0xf
    v_lshlrev_b32 v216, 16, v212
    v_and_b32 v217, s56, v212
    v_lshlrev_b32 v218, 16, v213
    v_and_b32 v219, s56, v213
    v_mov_b32_dpp v222, v216 quad_perm:[0,1,2,3] row_mask:0xf bank_mask:1
    s_nop 1
    v_mov_b32_dpp v222, v217 quad_perm:[0,1,2,3] row_mask:0xf bank_mask:2
    s_nop 1
    v_mov_b32_dpp v222, v218 quad_perm:[0,1,2,3] row_mask:0xf bank_mask:4
    s_nop 1
    v_mov_b32_dpp v222, v219 quad_perm:[0,1,2,3] row_mask:0xf bank_mask:8
    v_mov_b32_dpp v215, v208 quad_perm:[0,1,2,3] row_mask:0xf bank_mask:1
    s_nop 1
    v_mov_b32_dpp v215, v209 quad_perm:[0,1,2,3] row_mask:0xf bank_mask:2
    s_nop 1
    v_mov_b32_dpp v215, v210 quad_perm:[0,1,2,3] row_mask:0xf bank_mask:4
    s_nop 1
    v_mov_b32_dpp v215, v211 quad_perm:[0,1,2,3] row_mask:0xf bank_mask:8
    v_mov_b32 v216, 0
    v_mov_b32 v217, 0
    v_mov_b32 v218, 0
    v_mov_b32 v219, 0
    s_mov_b32 s86, 0x0f0f0f0f
    s_mov_b32 s87, 0x0f0f0f0f
    s_mov_b32 s88, 0xf0f0f0f0
    s_mov_b32 s89, 0xf0f0f0f0
    v_and_b32 v6, 3, v1
    v_lshlrev_b32 v6, 3, v6
    s_waitcnt vmcnt(4)
    v_perm_b32 v240, v132, v128, s54
    v_perm_b32 v241, v140, v136, s54
    v_perm_b32 v242, v132, v128, s55
    v_perm_b32 v243, v140, v136, s55
    v_mfma_f32_16x16x16_bf16 v[32:35], v[28:29], v[240:241], v[32:35]
    s_nop 0
    v_mfma_f32_16x16x16_bf16 v[36:39], v[28:29], v[242:243], v[36:39]
    v_perm_b32 v248, v133, v129, s54
    v_perm_b32 v249, v141, v137, s54
    v_perm_b32 v250, v133, v129, s55
    v_perm_b32 v251, v141, v137, s55
    v_mfma_f32_16x16x16_bf16 v[40:43], v[28:29], v[248:249], v[40:43]
    s_nop 0
    v_mfma_f32_16x16x16_bf16 v[44:47], v[28:29], v[250:251], v[44:47]
    v_perm_b32 v240, v134, v130, s54
    v_perm_b32 v241, v142, v138, s54
    v_perm_b32 v242, v134, v130, s55
    v_perm_b32 v243, v142, v138, s55
    v_mfma_f32_16x16x16_bf16 v[48:51], v[28:29], v[240:241], v[48:51]
    s_nop 0
    v_mfma_f32_16x16x16_bf16 v[52:55], v[28:29], v[242:243], v[52:55]
    v_perm_b32 v248, v135, v131, s54
    v_perm_b32 v249, v143, v139, s54
    v_perm_b32 v250, v135, v131, s55
    v_perm_b32 v251, v143, v139, s55
    v_mfma_f32_16x16x16_bf16 v[56:59], v[28:29], v[248:249], v[56:59]
    s_nop 0
    v_mfma_f32_16x16x16_bf16 v[60:63], v[28:29], v[250:251], v[60:63]
    s_waitcnt vmcnt(0)
    v_perm_b32 v240, v148, v144, s54
    v_perm_b32 v241, v156, v152, s54
    v_perm_b32 v242, v148, v144, s55
    v_perm_b32 v243, v156, v152, s55
    v_mfma_f32_16x16x16_bf16 v[32:35], v[30:31], v[240:241], v[32:35]
    s_nop 0
    v_mfma_f32_16x16x16_bf16 v[36:39], v[30:31], v[242:243], v[36:39]
    v_perm_b32 v248, v149, v145, s54
    v_perm_b32 v249, v157, v153, s54
    v_perm_b32 v250, v149, v145, s55
    v_perm_b32 v251, v157, v153, s55
    v_mfma_f32_16x16x16_bf16 v[40:43], v[30:31], v[248:249], v[40:43]
    s_nop 0
    v_mfma_f32_16x16x16_bf16 v[44:47], v[30:31], v[250:251], v[44:47]
    v_perm_b32 v240, v150, v146, s54
    v_perm_b32 v241, v158, v154, s54
    v_perm_b32 v242, v150, v146, s55
    v_perm_b32 v243, v158, v154, s55
    v_mfma_f32_16x16x16_bf16 v[48:51], v[30:31], v[240:241], v[48:51]
    s_nop 0
    v_mfma_f32_16x16x16_bf16 v[52:55], v[30:31], v[242:243], v[52:55]
    v_perm_b32 v248, v151, v147, s54
    v_perm_b32 v249, v159, v155, s54
    v_perm_b32 v250, v151, v147, s55
    v_perm_b32 v251, v159, v155, s55
    v_mfma_f32_16x16x16_bf16 v[56:59], v[30:31], v[248:249], v[56:59]
    s_nop 0
    v_mfma_f32_16x16x16_bf16 v[60:63], v[30:31], v[250:251], v[60:63]
    v_permlane32_swap_b32 v32, v48
    v_permlane32_swap_b32 v36, v52
    s_nop 3
    v_permlane32_swap_b32 v40, v56
    s_nop 0
    v_permlane32_swap_b32 v44, v60
    v_add_f32 v240, v32, v48
    v_add_f32 v241, v36, v52
    v_add_f32 v242, v40, v56
    v_add_f32 v243, v44, v60
    ds_write_b128 v10, v[240:243] offset:16384
    v_permlane32_swap_b32 v33, v49
    v_permlane32_swap_b32 v37, v53
    v_permlane32_swap_b32 v41, v57
    v_permlane32_swap_b32 v45, v61
    v_add_f32 v244, v33, v49
    v_add_f32 v245, v37, v53
    v_add_f32 v246, v41, v57
    v_add_f32 v247, v45, v61
    ds_write_b128 v10, v[244:247] offset:17408
    v_permlane32_swap_b32 v34, v50
    v_permlane32_swap_b32 v38, v54
    v_permlane32_swap_b32 v42, v58
    v_permlane32_swap_b32 v46, v62
    v_add_f32 v248, v34, v50
    v_add_f32 v249, v38, v54
    v_add_f32 v250, v42, v58
    v_add_f32 v251, v46, v62
    ds_write_b128 v10, v[248:251] offset:18432
    v_permlane32_swap_b32 v35, v51
    v_permlane32_swap_b32 v39, v55
    v_permlane32_swap_b32 v43, v59
    v_permlane32_swap_b32 v47, v63
    v_add_f32 v252, v35, v51
    v_add_f32 v253, v39, v55
    v_add_f32 v254, v43, v59
    v_add_f32 v255, v47, v63
    ds_write_b128 v10, v[252:255] offset:19456
    s_waitcnt lgkmcnt(0)
    s_barrier
    s_cmp_ge_u32 s3, 4
    s_cbranch_scc1 L_noh1
    s_lshl_b32 s6, s3, 10
    v_add_u32 v8, s6, v3
    ds_read_b128 v[32:35], v8 offset:16384
    ds_read_b128 v[36:39], v8 offset:20480
    ds_read_b128 v[40:43], v8 offset:24576
    ds_read_b128 v[44:47], v8 offset:28672
    ds_read_b128 v[48:51], v8 offset:32768
    ds_read_b128 v[52:55], v8 offset:36864
    ds_read_b128 v[56:59], v8 offset:40960
    ds_read_b128 v[60:63], v8 offset:45056
    s_waitcnt lgkmcnt(6)
    v_pk_add_f32 v[32:33], v[32:33], v[36:37]
    v_pk_add_f32 v[34:35], v[34:35], v[38:39]
    s_waitcnt lgkmcnt(5)
    v_pk_add_f32 v[32:33], v[32:33], v[40:41]
    v_pk_add_f32 v[34:35], v[34:35], v[42:43]
    s_waitcnt lgkmcnt(4)
    v_pk_add_f32 v[32:33], v[32:33], v[44:45]
    v_pk_add_f32 v[34:35], v[34:35], v[46:47]
    s_waitcnt lgkmcnt(3)
    v_pk_add_f32 v[32:33], v[32:33], v[48:49]
    v_pk_add_f32 v[34:35], v[34:35], v[50:51]
    s_waitcnt lgkmcnt(2)
    v_pk_add_f32 v[32:33], v[32:33], v[52:53]
    v_pk_add_f32 v[34:35], v[34:35], v[54:55]
    s_waitcnt lgkmcnt(1)
    v_pk_add_f32 v[32:33], v[32:33], v[56:57]
    v_pk_add_f32 v[34:35], v[34:35], v[58:59]
    s_waitcnt lgkmcnt(0)
    v_pk_add_f32 v[32:33], v[32:33], v[60:61]
    v_pk_add_f32 v[34:35], v[34:35], v[62:63]
    v_and_or_b32 v32, v32, v4, s51
    v_and_or_b32 v33, v33, v4, s51
    v_and_or_b32 v34, v34, v4, s51
    v_and_or_b32 v35, v35, v4, s51
    buffer_store_dwordx4 v[32:35], v11, s[16:19], s71 offen sc1
L_noh1:
    buffer_load_dwordx4 v[160:163], v13, s[32:35], s65 offen nt
    s_add_u32 s65, s65, 7168
    buffer_load_dwordx4 v[164:167], v13, s[32:35], s65 offen nt
    s_add_u32 s65, s65, 7168
    buffer_load_dwordx4 v[168:171], v13, s[32:35], s65 offen nt
    s_add_u32 s65, s65, 7168
    buffer_load_dwordx4 v[172:175], v13, s[32:35], s65 offen nt
    v_perm_b32 v224, v196, v192, s54
    v_perm_b32 v225, v204, v200, s54
    v_perm_b32 v228, v196, v192, s55
    v_perm_b32 v229, v204, v200, s55
    v_perm_b32 v232, v197, v193, s54
    v_perm_b32 v233, v205, v201, s54
    v_perm_b32 v236, v197, v193, s55
    v_perm_b32 v237, v205, v201, s55
    v_perm_b32 v226, v198, v194, s54
    v_perm_b32 v227, v206, v202, s54
    v_perm_b32 v230, v198, v194, s55
    v_perm_b32 v231, v206, v202, s55
    v_perm_b32 v234, v199, v195, s54
    v_perm_b32 v235, v207, v203, s54
    v_perm_b32 v238, v199, v195, s55
    v_perm_b32 v239, v207, v203, s55
    v_lshlrev_b32 v8, 3, v1
    s_lshr_b32 s6, s3, 1
    s_lshl_b32 s6, s6, 9
    v_add_u32 v30, s6, v8
    v_and_b32 v8, 15, v1
    v_lshlrev_b32 v8, 5, v8
    v_bfe_u32 v14, v1, 4, 1
    v_lshl_add_u32 v8, v14, 4, v8
    s_lshl_b32 s6, s3, 9
    v_add_u32 v31, s6, v8
    v_lshrrev_b32 v8, 4, v1
    s_lshl_b32 s6, s3, 2
    v_add_u32 v8, s6, v8
    v_mul_u32_u24 v8, 4224, v8
    v_and_b32 v14, 15, v1
    v_lshl_add_u32 v10, v14, 2, v8
    s_lshl_b32 s6, s3, 8
    v_add_u32 v220, s6, v214
    v_bfe_u32 v8, v1, 2, 2
    v_lshlrev_b32 v221, 3, v8
    s_mov_b32 s94, 0x88888888
    s_mov_b32 s95, 0x88888888
    s_lshr_b32 s6, s3, 1
    s_lshl_b32 s6, s6, 2
    v_mov_b32 v11, s6
    s_add_u32 s6, s74, 786432
    s_mov_b32 s62, 0
    s_sleep 16
    buffer_load_dwordx4 v[16:19], v3, s[16:19], s6 offen offset:0 sc1
    buffer_load_dwordx4 v[20:23], v3, s[16:19], s6 offen offset:1024 sc1
    s_waitcnt vmcnt(0)
L_pollc2:
    v_xor_b32 v16, s51, v16
    v_xor_b32 v17, s51, v17
    v_xor_b32 v18, s51, v18
    v_xor_b32 v19, s51, v19
    v_xor_b32 v20, s51, v20
    v_xor_b32 v21, s51, v21
    v_xor_b32 v22, s51, v22
    v_xor_b32 v23, s51, v23
    v_or3_b32 v14, v16, v17, v18
    v_or3_b32 v14, v14, v19, v20
    v_or3_b32 v14, v14, v21, v22
    v_or_b32 v14, v14, v23
    s_nop 1
    v_or_b32_dpp v14, v14, v14 quad_perm:[1,0,3,2] row_mask:0xf bank_mask:0xf
    v_cmp_ne_u32_sdwa vcc, v14, s79 src0_sel:BYTE_0 src1_sel:DWORD
    s_nop 0
    s_mov_b64 exec, vcc
    s_cbranch_execz L_polld2
    s_add_u32 s62, s62, 1
    s_cmp_gt_u32 s62, 0x80000
    s_cbranch_scc1 L_end
    buffer_load_dwordx4 v[16:19], v3, s[16:19], s6 offen offset:0 sc1
    buffer_load_dwordx4 v[20:23], v3, s[16:19], s6 offen offset:1024 sc1
    s_waitcnt vmcnt(0)
    s_branch L_pollc2
L_polld2:
    s_mov_b64 exec, -1
    v_pk_add_f32 v[16:17], v[16:17], v[20:21]
    v_pk_add_f32 v[18:19], v[18:19], v[22:23]
    s_nop 0
    v_permlane32_swap_b32 v16, v17
    v_permlane32_swap_b32 v18, v19
    v_add_f32 v16, v16, v17
    v_add_f32 v18, v18, v19
    s_nop 1
    v_permlane16_swap_b32 v16, v18
    v_add_f32 v16, v16, v18
    ds_write_b32 v7, v16 offset:8192
    s_waitcnt lgkmcnt(0)
    s_barrier
    ds_read_b64 v[20:21], v30 offset:8192
    s_waitcnt lgkmcnt(0)
    v_add_f32 v20, v20, v21
    s_nop 1
    v_add_f32_dpp v20, v20, v20 quad_perm:[1,0,3,2] row_mask:0xf bank_mask:0xf
    s_nop 1
    v_add_f32_dpp v20, v20, v20 quad_perm:[2,3,0,1] row_mask:0xf bank_mask:0xf
    v_cvt_pk_bf16_f32 v21, v20, v20
    s_nop 0
    v_mov_b32_dpp v16, v20 row_newbcast:0 row_mask:0xf bank_mask:0xf
    v_mov_b32_dpp v17, v20 row_newbcast:4 row_mask:0xf bank_mask:0xf
    v_mov_b32_dpp v18, v20 row_newbcast:8 row_mask:0xf bank_mask:0xf
    v_mov_b32_dpp v19, v20 row_newbcast:12 row_mask:0xf bank_mask:0xf
    v_lshlrev_b32 v21, 16, v21
    s_mov_b64 exec, s[86:87]
    v_cvt_pk_bf16_f32 v216, v16, v17
    v_cvt_pk_bf16_f32 v217, v18, v19
    s_mov_b64 exec, s[88:89]
    v_cvt_pk_bf16_f32 v218, v16, v17
    v_cvt_pk_bf16_f32 v219, v18, v19
    s_mov_b64 exec, -1
    v_mul_f32 v16, v21, v215
    v_mfma_f32_16x16x32_bf16 v[32:35], v[216:219], v[224:227], 0
    v_mfma_f32_16x16x32_bf16 v[36:39], v[216:219], v[228:231], 0
    v_add_f32_dpp v16, v16, v16 row_ror:4 row_mask:0xf bank_mask:0xf
    v_mfma_f32_16x16x32_bf16 v[40:43], v[216:219], v[232:235], 0
    v_mfma_f32_16x16x32_bf16 v[44:47], v[216:219], v[236:239], 0
    v_add_f32_dpp v16, v16, v16 row_ror:8 row_mask:0xf bank_mask:0xf
    v_mov_b32 v8, v16
    s_nop 1
    v_permlane32_swap_b32 v8, v16
    v_add_f32 v16, v16, v8
    v_mov_b32 v8, v16
    s_nop 1
    v_permlane16_swap_b32 v8, v16
    v_add_f32 v16, v16, v8
    ds_write_b32 v11, v16 offset:7168
    v_mov_b32 v26, v32
    v_mov_b32 v27, v36
    v_mov_b32 v28, v40
    v_mov_b32 v29, v44
    ds_write_b128 v31, v[26:29] offset:12288
    s_waitcnt lgkmcnt(0)
    s_barrier
    s_add_u32 s78, s75, 458752
    s_cmp_ge_u32 s3, 4
    s_cbranch_scc1 L_nob
    v_mov_b32 v8, 0
    ds_read_b128 v[16:19], v8 offset:7168
    ds_read2st64_b32 v[32:33], v220 offset0:48 offset1:52
    ds_read2st64_b32 v[34:35], v220 offset0:56 offset1:60
    s_waitcnt lgkmcnt(2)
    v_add_f32 v16, v16, v17
    v_add_f32 v18, v18, v19
    v_add_f32 v16, v16, v18
    v_bfe_u32 v16, v16, v221, 8
    v_mov_b32 v8, s51
    v_cndmask_b32 v16, v8, v16, s[94:95]
    s_waitcnt lgkmcnt(0)
    v_add_f32 v32, v32, v33
    v_add_f32 v34, v34, v35
    v_add_f32 v32, v32, v34
    v_and_or_b32 v32, v32, v4, v16
    buffer_store_dword v32, v10, s[16:19], s78 offen sc1
L_nob:
    s_cmp_ge_u32 s3, 4
    s_cbranch_scc1 L_g2s
    s_add_u32 s6, s76, 458752
    s_mov_b32 s62, 0
    s_sleep 16
    buffer_load_dwordx4 v[16:19], v3, s[16:19], s6 offen offset:0 sc1
    s_waitcnt vmcnt(1)
    v_perm_b32 v224, v164, v160, s54
    v_perm_b32 v225, v172, v168, s54
    v_perm_b32 v228, v164, v160, s55
    v_perm_b32 v229, v172, v168, s55
    v_perm_b32 v232, v165, v161, s54
    v_perm_b32 v233, v173, v169, s54
    v_perm_b32 v236, v165, v161, s55
    v_perm_b32 v237, v173, v169, s55
    v_perm_b32 v226, v166, v162, s54
    v_perm_b32 v227, v174, v170, s54
    v_perm_b32 v230, v166, v162, s55
    v_perm_b32 v231, v174, v170, s55
    v_perm_b32 v234, v167, v163, s54
    v_perm_b32 v235, v175, v171, s54
    v_perm_b32 v238, v167, v163, s55
    v_perm_b32 v239, v175, v171, s55
    s_waitcnt vmcnt(0)
L_pollc3:
    v_xor_b32 v16, s51, v16
    v_xor_b32 v17, s51, v17
    v_xor_b32 v18, s51, v18
    v_or3_b32 v14, v16, v17, v18
    s_nop 1
    v_or_b32_dpp v14, v14, v14 quad_perm:[1,0,3,2] row_mask:0xf bank_mask:0xf
    v_cmp_ne_u32_sdwa vcc, v14, s79 src0_sel:BYTE_0 src1_sel:DWORD
    s_nop 0
    s_mov_b64 exec, vcc
    s_cbranch_execz L_polld3
    s_add_u32 s62, s62, 1
    s_cmp_gt_u32 s62, 0x80000
    s_cbranch_scc1 L_end
    buffer_load_dwordx4 v[16:19], v3, s[16:19], s6 offen offset:0 sc1
    s_waitcnt vmcnt(0)
    s_branch L_pollc3
L_polld3:
    s_mov_b64 exec, -1
    v_and_b32 v20, 0xff, v19
    v_lshlrev_b32 v20, v6, v20
    v_and_or_b32 v19, v19, v4, s59
    s_nop 0
    v_or_b32_dpp v20, v20, v20 quad_perm:[1,0,3,2] row_mask:0xf bank_mask:0xf
    v_permlane32_swap_b32 v16, v17
    v_permlane32_swap_b32 v18, v19
    v_or_b32_dpp v20, v20, v20 quad_perm:[2,3,0,1] row_mask:0xf bank_mask:0xf
    v_add_f32 v16, v16, v17
    v_add_f32 v18, v18, v19
    v_add_f32_dpp v20, v20, v20 row_ror:4 row_mask:0xf bank_mask:0xf
    s_lshl_b32 s6, s3, 2
    v_mov_b32 v8, s6
    v_permlane16_swap_b32 v16, v18
    v_add_f32_dpp v20, v20, v20 row_ror:8 row_mask:0xf bank_mask:0xf
    v_add_f32 v16, v16, v18
    v_mov_b32 v21, v20
    s_nop 0
    v_add_f32_dpp v16, v16, v16 row_ror:4 row_mask:0xf bank_mask:0xf
    v_permlane16_swap_b32 v21, v20
    v_add_f32 v20, v20, v21
    v_add_f32_dpp v16, v16, v16 row_ror:8 row_mask:0xf bank_mask:0xf
    v_mov_b32 v21, v20
    ds_write_b32 v9, v16 offset:6912
    s_nop 0
    v_permlane32_swap_b32 v21, v20
    v_add_f32 v20, v20, v21
    ds_write_b32 v8, v20 offset:7200
    s_branch L_g2
L_g2s:
    s_waitcnt vmcnt(0)
    buffer_load_dwordx4 v[176:179], v12, s[36:39], s66 offen nt
    s_add_u32 s66, s66, 2048
    buffer_load_dwordx4 v[180:183], v12, s[36:39], s66 offen nt
    s_add_u32 s66, s66, 2048
    buffer_load_dwordx4 v[184:187], v12, s[36:39], s66 offen nt
    s_add_u32 s66, s66, 2048
    buffer_load_dwordx4 v[188:191], v12, s[36:39], s66 offen nt
    v_perm_b32 v224, v164, v160, s54
    v_perm_b32 v225, v172, v168, s54
    v_perm_b32 v228, v164, v160, s55
    v_perm_b32 v229, v172, v168, s55
    v_perm_b32 v232, v165, v161, s54
    v_perm_b32 v233, v173, v169, s54
    v_perm_b32 v236, v165, v161, s55
    v_perm_b32 v237, v173, v169, s55
    v_perm_b32 v226, v166, v162, s54
    v_perm_b32 v227, v174, v170, s54
    v_perm_b32 v230, v166, v162, s55
    v_perm_b32 v231, v174, v170, s55
    v_perm_b32 v234, v167, v163, s54
    v_perm_b32 v235, v175, v171, s54
    v_perm_b32 v238, v167, v163, s55
    v_perm_b32 v239, v175, v171, s55
L_g2:
    s_cmp_ge_u32 s3, 4
    s_cbranch_scc1 L_w2s
L_w2s:
    s_waitcnt lgkmcnt(0)
    s_barrier
    v_mov_b32 v8, 0
    ds_read_b32 v20, v214 offset:6912
    ds_read_b128 v[16:19], v8 offset:7200
    v_mov_b32 v14, s92
    s_waitcnt lgkmcnt(0)
    v_add_f32_dpp v20, v20, v20 quad_perm:[1,0,3,2] row_mask:0xf bank_mask:0xf
    v_add_f32 v16, v16, v17
    v_add_f32 v18, v18, v19
    v_add_f32_dpp v20, v20, v20 quad_perm:[2,3,0,1] row_mask:0xf bank_mask:0xf
    v_add_f32 v16, v16, v18
    v_fmac_f32 v14, 0x3a800000, v16
    v_cvt_pk_bf16_f32 v14, v14, v14
    v_lshlrev_b32 v14, 16, v14
    v_cvt_pk_bf16_f32 v20, v20, v20
    v_lshlrev_b32 v20, 16, v20
    v_add_f32 v20, v20, v222
    v_cvt_pk_bf16_f32 v222, v20, v20
    v_lshlrev_b32 v222, 16, v222
    v_sub_f32 v20, v222, v14
    s_nop 1
    v_mov_b32_dpp v16, v20 row_newbcast:0 row_mask:0xf bank_mask:0xf
    v_mov_b32_dpp v17, v20 row_newbcast:4 row_mask:0xf bank_mask:0xf
    v_mov_b32_dpp v18, v20 row_newbcast:8 row_mask:0xf bank_mask:0xf
    v_mov_b32_dpp v19, v20 row_newbcast:12 row_mask:0xf bank_mask:0xf
    s_cmp_eq_u32 s3, 7
    s_cbranch_scc1 L_stat
    s_mov_b64 exec, s[86:87]
    v_cvt_pk_bf16_f32 v216, v16, v17
    v_cvt_pk_bf16_f32 v217, v18, v19
    s_mov_b64 exec, s[88:89]
    v_cvt_pk_bf16_f32 v218, v16, v17
    v_cvt_pk_bf16_f32 v219, v18, v19
    s_mov_b64 exec, -1
    s_nop 0
    v_mfma_f32_16x16x32_bf16 v[32:35], v[216:219], v[224:227], 0
    v_mfma_f32_16x16x32_bf16 v[36:39], v[216:219], v[228:231], 0
    v_mfma_f32_16x16x32_bf16 v[40:43], v[216:219], v[232:235], 0
    v_mfma_f32_16x16x32_bf16 v[44:47], v[216:219], v[236:239], 0
    s_nop 4
    v_and_or_b32 v26, v32, v4, s51
    v_and_or_b32 v27, v36, v4, s51
    v_and_or_b32 v28, v40, v4, s51
    v_and_or_b32 v29, v44, v4, s51
    s_mov_b32 exec_hi, 0
    buffer_store_dwordx4 v[26:29], v5, s[16:19], s73 offen sc1
    s_branch L_cd
L_stat:
    s_nop 0
    v_add_f32 v26, v16, v17
    v_add_f32 v8, v18, v19
    v_mul_f32 v27, v16, v16
    v_add_f32 v26, v26, v8
    v_fmac_f32 v27, v17, v17
    v_fmac_f32 v27, v18, v18
    v_fmac_f32 v27, v19, v19
    v_mov_b32 v8, v26
    s_nop 1
    v_permlane32_swap_b32 v8, v26
    v_add_f32 v26, v26, v8
    v_mov_b32 v8, v26
    s_nop 1
    v_permlane16_swap_b32 v8, v26
    v_add_f32 v26, v26, v8
    v_mov_b32 v14, v27
    s_nop 1
    v_permlane32_swap_b32 v14, v27
    v_add_f32 v27, v27, v14
    v_mov_b32 v14, v27
    s_nop 1
    v_permlane16_swap_b32 v14, v27
    v_add_f32 v27, v27, v14
    v_and_or_b32 v26, v26, v4, s51
    v_and_or_b32 v27, v27, v4, s51
    v_mov_b32 v28, s53
    v_mov_b32 v29, s53
    v_lshlrev_b32 v8, 10, v1
    s_lshl_b32 s6, s91, 11
    s_lshl_b32 s7, s90, 4
    s_add_u32 s6, s6, s7
    s_add_u32 s6, s6, 294912
    s_mov_b64 exec, 3
    buffer_store_dwordx4 v[26:29], v8, s[16:19], s6 offen sc1
    s_cmp_lg_u32 s2, 0
    s_cbranch_scc1 L_cd
    s_mov_b64 exec, 1
    buffer_store_dword v28, v8, s[16:19], 0 offen offset:0 sc1
L_cd:
    s_mov_b64 exec, -1
    s_cmp_ge_u32 s3, 4
    s_cbranch_scc1 L_w2t
    buffer_load_dwordx4 v[176:179], v12, s[36:39], s66 offen nt
    s_add_u32 s66, s66, 2048
    buffer_load_dwordx4 v[180:183], v12, s[36:39], s66 offen nt
    s_add_u32 s66, s66, 2048
    buffer_load_dwordx4 v[184:187], v12, s[36:39], s66 offen nt
    s_add_u32 s66, s66, 2048
    buffer_load_dwordx4 v[188:191], v12, s[36:39], s66 offen nt
L_w2t:
    s_cmp_ge_u32 s90, 56
    s_cbranch_scc1 L_nod
    s_add_u32 s6, s74, 2097152
    s_cmp_eq_u32 s3, 7
    s_cbranch_scc1 L_g4s
    s_lshr_b32 s78, s3, 1
    s_cmp_eq_u32 s78, 2
    s_cbranch_scc1 L_g4t
    s_mov_b32 s62, 0
    s_sleep 16
    buffer_load_dwordx4 v[16:19], v3, s[16:19], s6 offen offset:0 sc1
    buffer_load_dwordx4 v[20:23], v3, s[16:19], s6 offen offset:1024 sc1
    s_waitcnt vmcnt(2)
    v_perm_b32 v224, v180, v176, s54
    v_perm_b32 v225, v188, v184, s54
    v_perm_b32 v228, v180, v176, s55
    v_perm_b32 v229, v188, v184, s55
    v_perm_b32 v232, v181, v177, s54
    v_perm_b32 v233, v189, v185, s54
    v_perm_b32 v236, v181, v177, s55
    v_perm_b32 v237, v189, v185, s55
    v_perm_b32 v226, v182, v178, s54
    v_perm_b32 v227, v190, v186, s54
    v_perm_b32 v230, v182, v178, s55
    v_perm_b32 v231, v190, v186, s55
    v_perm_b32 v234, v183, v179, s54
    v_perm_b32 v235, v191, v187, s54
    v_perm_b32 v238, v183, v179, s55
    v_perm_b32 v239, v191, v187, s55
    s_waitcnt vmcnt(0)
L_pollc4:
    v_xor_b32 v16, s51, v16
    v_xor_b32 v17, s51, v17
    v_xor_b32 v18, s51, v18
    v_xor_b32 v19, s51, v19
    v_xor_b32 v20, s51, v20
    v_xor_b32 v21, s51, v21
    v_xor_b32 v22, s51, v22
    v_xor_b32 v23, s51, v23
    v_or3_b32 v14, v16, v17, v18
    v_or3_b32 v14, v14, v19, v20
    v_or3_b32 v14, v14, v21, v22
    v_or_b32 v14, v14, v23
    s_nop 1
    v_or_b32_dpp v14, v14, v14 quad_perm:[1,0,3,2] row_mask:0xf bank_mask:0xf
    v_cmp_ne_u32_sdwa vcc, v14, s79 src0_sel:BYTE_0 src1_sel:DWORD
    s_nop 0
    s_mov_b64 exec, vcc
    s_cbranch_execz L_polld4
    s_add_u32 s62, s62, 1
    s_cmp_gt_u32 s62, 0x80000
    s_cbranch_scc1 L_end
    buffer_load_dwordx4 v[16:19], v3, s[16:19], s6 offen offset:0 sc1
    buffer_load_dwordx4 v[20:23], v3, s[16:19], s6 offen offset:1024 sc1
    s_waitcnt vmcnt(0)
    s_branch L_pollc4
L_polld4:
    s_mov_b64 exec, -1
    v_pk_add_f32 v[16:17], v[16:17], v[20:21]
    v_pk_add_f32 v[18:19], v[18:19], v[22:23]
    s_nop 0
    v_permlane32_swap_b32 v16, v17
    v_permlane32_swap_b32 v18, v19
    v_add_f32 v16, v16, v17
    v_add_f32 v18, v18, v19
    s_nop 1
    v_permlane16_swap_b32 v16, v18
    v_add_f32 v16, v16, v18
    ds_write_b32 v7, v16 offset:10240
    s_branch L_g4
L_g4t:
    s_lshl_b32 s78, s3, 10
    s_sub_u32 s78, s6, s78
    s_add_u32 s78, s78, 10240
    s_mov_b32 s62, 0
    s_sleep 16
    buffer_load_dwordx4 v[16:19], v3, s[16:19], s6 offen offset:0 sc1
    buffer_load_dwordx4 v[20:23], v3, s[16:19], s6 offen offset:1024 sc1
    buffer_load_dwordx4 v[24:27], v3, s[16:19], s78 offen offset:0 sc1
    s_waitcnt vmcnt(3)
    v_perm_b32 v224, v180, v176, s54
    v_perm_b32 v225, v188, v184, s54
    v_perm_b32 v228, v180, v176, s55
    v_perm_b32 v229, v188, v184, s55
    v_perm_b32 v232, v181, v177, s54
    v_perm_b32 v233, v189, v185, s54
    v_perm_b32 v236, v181, v177, s55
    v_perm_b32 v237, v189, v185, s55
    v_perm_b32 v226, v182, v178, s54
    v_perm_b32 v227, v190, v186, s54
    v_perm_b32 v230, v182, v178, s55
    v_perm_b32 v231, v190, v186, s55
    v_perm_b32 v234, v183, v179, s54
    v_perm_b32 v235, v191, v187, s54
    v_perm_b32 v238, v183, v179, s55
    v_perm_b32 v239, v191, v187, s55
    s_waitcnt vmcnt(0)
L_pollc5:
    v_xor_b32 v16, s51, v16
    v_xor_b32 v17, s51, v17
    v_xor_b32 v18, s51, v18
    v_xor_b32 v19, s51, v19
    v_xor_b32 v20, s51, v20
    v_xor_b32 v21, s51, v21
    v_xor_b32 v22, s51, v22
    v_xor_b32 v23, s51, v23
    v_xor_b32 v24, s51, v24
    v_xor_b32 v25, s51, v25
    v_xor_b32 v26, s51, v26
    v_xor_b32 v27, s51, v27
    v_or3_b32 v14, v16, v17, v18
    v_or3_b32 v14, v14, v19, v20
    v_or3_b32 v14, v14, v21, v22
    v_or3_b32 v14, v14, v23, v24
    v_or3_b32 v14, v14, v25, v26
    v_or_b32 v14, v14, v27
    s_nop 1
    v_or_b32_dpp v14, v14, v14 quad_perm:[1,0,3,2] row_mask:0xf bank_mask:0xf
    v_cmp_ne_u32_sdwa vcc, v14, s79 src0_sel:BYTE_0 src1_sel:DWORD
    s_nop 0
    s_mov_b64 exec, vcc
    s_cbranch_execz L_polld5
    s_add_u32 s62, s62, 1
    s_cmp_gt_u32 s62, 0x80000
    s_cbranch_scc1 L_end
    buffer_load_dwordx4 v[16:19], v3, s[16:19], s6 offen offset:0 sc1
    buffer_load_dwordx4 v[20:23], v3, s[16:19], s6 offen offset:1024 sc1
    buffer_load_dwordx4 v[24:27], v3, s[16:19], s78 offen offset:0 sc1
    s_waitcnt vmcnt(0)
    s_branch L_pollc5
L_polld5:
    s_mov_b64 exec, -1
    v_pk_add_f32 v[20:21], v[20:21], v[24:25]
    v_pk_add_f32 v[22:23], v[22:23], v[26:27]
    v_pk_add_f32 v[16:17], v[16:17], v[20:21]
    v_pk_add_f32 v[18:19], v[18:19], v[22:23]
    s_nop 0
    v_permlane32_swap_b32 v16, v17
    v_permlane32_swap_b32 v18, v19
    v_add_f32 v16, v16, v17
    v_add_f32 v18, v18, v19
    s_nop 1
    v_permlane16_swap_b32 v16, v18
    v_add_f32 v16, v16, v18
    ds_write_b32 v7, v16 offset:10240
    s_branch L_g4
L_g4s:
    s_add_u32 s7, s77, 294912
    v_mov_b32 v16, 0
    ds_write_b32 v7, v16 offset:10240
    s_mov_b32 s62, 0
    s_sleep 16
    buffer_load_dwordx4 v[26:29], v3, s[16:19], s7 offen offset:0 sc1
    s_waitcnt vmcnt(1)
    v_perm_b32 v224, v180, v176, s54
    v_perm_b32 v225, v188, v184, s54
    v_perm_b32 v228, v180, v176, s55
    v_perm_b32 v229, v188, v184, s55
    v_perm_b32 v232, v181, v177, s54
    v_perm_b32 v233, v189, v185, s54
    v_perm_b32 v236, v181, v177, s55
    v_perm_b32 v237, v189, v185, s55
    v_perm_b32 v226, v182, v178, s54
    v_perm_b32 v227, v190, v186, s54
    v_perm_b32 v230, v182, v178, s55
    v_perm_b32 v231, v190, v186, s55
    v_perm_b32 v234, v183, v179, s54
    v_perm_b32 v235, v191, v187, s54
    v_perm_b32 v238, v183, v179, s55
    v_perm_b32 v239, v191, v187, s55
    s_waitcnt vmcnt(0)
L_pollc6:
    v_xor_b32 v26, s51, v26
    v_xor_b32 v27, s51, v27
    v_or_b32 v14, v26, v27
    s_nop 1
    v_or_b32_dpp v14, v14, v14 quad_perm:[1,0,3,2] row_mask:0xf bank_mask:0xf
    v_and_b32 v14, 0xff, v14
    v_bitop3_b32 v14, v28, s53, v14 bitop3:0xbe
    v_cmp_ne_u32 vcc, 0, v14
    s_nop 0
    s_mov_b64 exec, vcc
    s_cbranch_execz L_polld6
    s_add_u32 s62, s62, 1
    s_cmp_gt_u32 s62, 0x80000
    s_cbranch_scc1 L_end
    buffer_load_dwordx4 v[26:29], v3, s[16:19], s7 offen offset:0 sc1
    s_waitcnt vmcnt(0)
    s_branch L_pollc6
L_polld6:
    s_mov_b64 exec, -1
    v_permlane32_swap_b32 v26, v27
    v_add_f32 v16, v26, v27
    v_mov_b32 v8, v16
    s_nop 1
    v_permlane16_swap_b32 v8, v16
    v_add_f32 v16, v16, v8
    s_nop 1
    v_add_f32_dpp v16, v16, v16 row_ror:8 row_mask:0xf bank_mask:0xf
    s_nop 1
    v_add_f32_dpp v16, v16, v16 row_ror:4 row_mask:0xf bank_mask:0xf
    s_nop 1
    v_add_f32_dpp v16, v16, v16 row_ror:2 row_mask:0xf bank_mask:0xf
    s_nop 1
    v_add_f32_dpp v16, v16, v16 row_ror:1 row_mask:0xf bank_mask:0xf
    v_mul_f32 v16, 0x3a800000, v16
    v_mov_b32 v8, v16
    s_nop 1
    v_permlane32_swap_b32 v8, v16
    v_fma_f32 v16, -v8, v8, v16
    v_max_f32 v16, 0, v16
    v_cvt_pk_bf16_f32 v16, v16, v16
    v_lshlrev_b32 v16, 16, v16
    v_add_f32 v16, 0x3727c5ac, v16
    v_cvt_pk_bf16_f32 v16, v16, v16
    v_lshlrev_b32 v16, 16, v16
    v_sqrt_f32 v16, v16
    s_nop 0
    v_cvt_pk_bf16_f32 v16, v16, v16
    v_lshlrev_b32 v16, 16, v16
    v_rcp_f32 v16, v16
    v_mov_b32 v8, 0
    ds_write_b32 v8, v16 offset:7188
L_g4:
    s_waitcnt lgkmcnt(0)
    s_barrier
    v_mov_b32 v8, 0
    ds_read_b64 v[20:21], v30 offset:10240
    ds_read_b32 v14, v8 offset:7188
    s_waitcnt lgkmcnt(1)
    v_add_f32 v20, v20, v21
    s_nop 1
    v_add_f32_dpp v20, v20, v20 quad_perm:[1,0,3,2] row_mask:0xf bank_mask:0xf
    s_nop 1
    v_add_f32_dpp v20, v20, v20 quad_perm:[2,3,0,1] row_mask:0xf bank_mask:0xf
    s_waitcnt lgkmcnt(0)
    v_mul_f32 v20, v20, v14
    v_cvt_pk_bf16_f32 v20, v20, v20
    v_lshlrev_b32 v20, 16, v20
    v_mul_f32 v21, s58, v20
    v_exp_f32 v21, -v21
    s_nop 0
    v_add_f32 v21, 1.0, v21
    v_rcp_f32 v21, v21
    s_nop 0
    v_mul_f32 v20, v20, v21
    s_nop 1
    v_mov_b32_dpp v16, v20 row_newbcast:0 row_mask:0xf bank_mask:0xf
    v_mov_b32_dpp v17, v20 row_newbcast:4 row_mask:0xf bank_mask:0xf
    v_mov_b32_dpp v18, v20 row_newbcast:8 row_mask:0xf bank_mask:0xf
    v_mov_b32_dpp v19, v20 row_newbcast:12 row_mask:0xf bank_mask:0xf
    s_mov_b64 exec, s[86:87]
    v_cvt_pk_bf16_f32 v216, v16, v17
    v_cvt_pk_bf16_f32 v217, v18, v19
    s_mov_b64 exec, s[88:89]
    v_cvt_pk_bf16_f32 v218, v16, v17
    v_cvt_pk_bf16_f32 v219, v18, v19
    s_mov_b64 exec, -1
    s_nop 0
    v_mfma_f32_16x16x32_bf16 v[32:35], v[216:219], v[224:227], 0
    v_mfma_f32_16x16x32_bf16 v[36:39], v[216:219], v[228:231], 0
    v_mfma_f32_16x16x32_bf16 v[40:43], v[216:219], v[232:235], 0
    v_mfma_f32_16x16x32_bf16 v[44:47], v[216:219], v[236:239], 0
    s_nop 4
    v_mov_b32 v26, v32
    v_mov_b32 v27, v36
    v_mov_b32 v28, v40
    v_mov_b32 v29, v44
    ds_write_b128 v31, v[26:29] offset:16384
    s_waitcnt lgkmcnt(0)
    s_barrier
    s_add_u32 s78, s75, 3145728
    s_cmp_ge_u32 s3, 4
    s_cbranch_scc1 L_nod
    ds_read2st64_b32 v[32:33], v220 offset0:64 offset1:68
    ds_read2st64_b32 v[34:35], v220 offset0:72 offset1:76
    s_waitcnt lgkmcnt(0)
    v_add_f32 v32, v32, v33
    v_add_f32 v34, v34, v35
    v_add_f32 v32, v32, v34
    v_and_or_b32 v32, v32, v4, s51
    buffer_store_dword v32, v10, s[16:19], s78 offen sc1
L_nod:
    s_cmp_lg_u32 s91, 0
    s_cbranch_scc1 L_fin
    s_cmp_ge_u32 s3, 4
    s_cbranch_scc1 L_g5
    v_mov_b32 v16, 0
    v_mov_b32 v17, 0
    v_mov_b32 v18, 0
    v_mov_b32 v19, 0
    s_add_u32 s6, s76, 3145728
    s_cmp_eq_u32 s3, 3
    s_cselect_b32 exec_hi, 0, -1
    s_mov_b32 s62, 0
    s_sleep 16
    buffer_load_dwordx4 v[16:19], v3, s[16:19], s6 offen offset:0 sc1
    s_waitcnt vmcnt(0)
L_pollc7:
    v_xor_b32 v16, s51, v16
    v_xor_b32 v17, s51, v17
    v_xor_b32 v18, s51, v18
    v_xor_b32 v19, s51, v19
    v_or3_b32 v14, v16, v17, v18
    v_or_b32 v14, v14, v19
    s_nop 1
    v_or_b32_dpp v14, v14, v14 quad_perm:[1,0,3,2] row_mask:0xf bank_mask:0xf
    v_cmp_ne_u32_sdwa vcc, v14, s79 src0_sel:BYTE_0 src1_sel:DWORD
    s_nop 0
    s_mov_b64 exec, vcc
    s_cbranch_execz L_polld7
    s_add_u32 s62, s62, 1
    s_cmp_gt_u32 s62, 0x80000
    s_cbranch_scc1 L_end
    buffer_load_dwordx4 v[16:19], v3, s[16:19], s6 offen offset:0 sc1
    s_waitcnt vmcnt(0)
    s_branch L_pollc7
L_polld7:
    s_mov_b64 exec, -1
    v_permlane32_swap_b32 v16, v17
    v_permlane32_swap_b32 v18, v19
    v_add_f32 v16, v16, v17
    v_add_f32 v18, v18, v19
    s_nop 1
    v_permlane16_swap_b32 v16, v18
    v_add_f32 v16, v16, v18
    s_nop 1
    v_add_f32_dpp v16, v16, v16 row_ror:4 row_mask:0xf bank_mask:0xf
    s_nop 1
    v_add_f32_dpp v16, v16, v16 row_ror:8 row_mask:0xf bank_mask:0xf
    ds_write_b32 v9, v16 offset:7424
L_g5:
    s_waitcnt lgkmcnt(0)
    s_barrier
    s_cmp_lg_u32 s3, 0
    s_cbranch_scc1 L_fin
    ds_read_b32 v20, v214 offset:7424
    v_lshrrev_b32 v8, 2, v1
    v_lshlrev_b32 v8, 1, v8
    s_lshl_b32 s6, s90, 5
    s_waitcnt lgkmcnt(0)
    v_add_f32_dpp v20, v20, v20 quad_perm:[1,0,3,2] row_mask:0xf bank_mask:0xf
    s_nop 1
    v_add_f32_dpp v20, v20, v20 quad_perm:[2,3,0,1] row_mask:0xf bank_mask:0xf
    v_cvt_pk_bf16_f32 v20, v20, v20
    v_lshlrev_b32 v20, 16, v20
    v_add_f32 v20, v20, v222
    v_cvt_pk_bf16_f32 v20, v20, v20
    s_mov_b32 exec_lo, 0x11111111
    s_mov_b32 exec_hi, 0x11111111
    buffer_store_short v20, v8, s[40:43], s6 offen
    s_mov_b64 exec, -1
L_fin:
L_end:
    s_endpgm
.section .rodata,"a"
.p2align 6
.amdhsa_kernel sequential_preLN__gqa_block_cached__dense_activation_silu__decode_kernel
  .amdhsa_next_free_vgpr 256
  .amdhsa_next_free_sgpr 102
  .amdhsa_accum_offset 256
  .amdhsa_group_segment_fixed_size 0
  .amdhsa_kernarg_size 88
  .amdhsa_user_sgpr_count 2
  .amdhsa_user_sgpr_kernarg_segment_ptr 1
  .amdhsa_system_sgpr_workgroup_id_x 1
.end_amdhsa_kernel
```
